```python
import torch

def _softmax(x, axis=-1):
    return torch.softmax(x, dim=axis)
def _gelu(x):
    return torch.nn.functional.gelu(x, approximate="tanh")
def _silu(x):
    return torch.nn.functional.silu(x)
def _sigmoid(x):
    return torch.sigmoid(x)
def _layernorm(x, axis=-1, eps=1e-5):
    m = x.mean(dim=axis, keepdim=True)
    v = x.var(dim=axis, keepdim=True, unbiased=False)
    return (x - m) / torch.sqrt(v + eps)
def _scatter_add(tgt, idx, src, axis=0):
    return tgt.clone().index_add_(axis, idx, src)
def _segment_sum(src, seg, n):
    out = torch.zeros((n,) + src.shape[1:], dtype=src.dtype)
    return out.index_add_(0, seg, src)
def _pad(x, pw):
    flat = tuple(v for pair in reversed(pw) for v in pair)
    return torch.nn.functional.pad(x, flat)

kernel_name = 'recurrent_scan__spectral_fnet__mixer_s_mlp__prompt'

def setup_inputs():

    _w = (lambda a: (lambda t: t.to(torch.bfloat16) if t.is_floating_point() else t)(torch.as_tensor(a)))
    def _A_setup():
        B, S, D = 1, 2048, 512
        ns = torch.arange(S)[:, None] * torch.arange(S)[None, :]
        nd = torch.arange(D)[:, None] * torch.arange(D)[None, :]
        Ws_re = torch.cos(-2.0 * torch.pi * ns / S).to(float)
        Ws_im = torch.sin(-2.0 * torch.pi * ns / S).to(float)
        Wd_re = torch.cos(-2.0 * torch.pi * nd / D).to(float)
        Wd_im = torch.sin(-2.0 * torch.pi * nd / D).to(float)
        return {
            "x": _w((lambda *s: torch.randn(*s, dtype=torch.bfloat16) * 0.05)(B, S, D)),
            "dft_seq_re": _w(Ws_re),
            "dft_seq_im": _w(Ws_im),
            "dft_hid_re": _w(Wd_re),
            "dft_hid_im": _w(Wd_im),
        }
    _A_in = _A_setup()

    def _B_setup():
        B, S, D, F = 1, 2048, 512, 1376
        return {
            "x":  _w((lambda *s: torch.randn(*s, dtype=torch.bfloat16) * 0.05)(B, S, D)),
            "w1": _w((lambda *s: torch.randn(*s, dtype=torch.bfloat16) * 3.2)(D, D) * (D ** -0.5)),
            "w2": _w((lambda *s: torch.randn(*s, dtype=torch.bfloat16) * 3.2)(D, D) * (D ** -0.5)),
            "w3": _w((lambda *s: torch.randn(*s, dtype=torch.bfloat16) * 3.2)(D, F) * (D ** -0.5)),
            "w4": _w((lambda *s: torch.randn(*s, dtype=torch.bfloat16) * 3.2)(F, D) * (F ** -0.5)),
        }
    _B_in = _B_setup()

    return {
        "A_x": _A_in["x"],
        "A_dft_seq_re": _A_in["dft_seq_re"],
        "A_dft_seq_im": _A_in["dft_seq_im"],
        "A_dft_hid_re": _A_in["dft_hid_re"],
        "A_dft_hid_im": _A_in["dft_hid_im"],
        "B_x": _B_in["x"],
        "B_w1": _B_in["w1"],
        "B_w2": _B_in["w2"],
        "B_w3": _B_in["w3"],
        "B_w4": _B_in["w4"],
    }

def reference(A_x, A_dft_seq_re, A_dft_seq_im, A_dft_hid_re, A_dft_hid_im, B_x, B_w1, B_w2, B_w3, B_w4):
    def _A_ref(x, dft_seq_re, dft_seq_im, dft_hid_re, dft_hid_im):
        a = torch.einsum("bsd,ed->bse", x, dft_hid_re)
        b = torch.einsum("bsd,ed->bse", x, dft_hid_im)
        y = torch.einsum("ts,bse->bte", dft_seq_re, a) - torch.einsum("ts,bse->bte", dft_seq_im, b)
        return y

    def _B_ref(x, w1, w2, w3, w4):
        B, S, D = x.shape
        h = _gelu(_layernorm(x, axis=-1) @ w1)
        c = D // 4
        g0 = _pad(h[:, :, 0*c:1*c], ((0, 0), (1, 0), (0, 0)))[:, :S, :]
        g1 = _pad(h[:, :, 1*c:2*c], ((0, 0), (0, 1), (0, 0)))[:, 1:, :]
        g2 = _pad(h[:, :, 2*c:3*c], ((0, 0), (2, 0), (0, 0)))[:, :S, :]
        g3 = _pad(h[:, :, 3*c:   ], ((0, 0), (0, 2), (0, 0)))[:, 2:, :]
        hs = torch.concatenate([g0, g1, g2, g3], axis=-1) @ w2
        x1 = x + hs
        h2 = _gelu(_layernorm(x1, axis=-1) @ w3) @ w4
        return x1 + h2

    x = A_x
    xn = _layernorm(x, axis=-1)
    s = _A_ref(xn, A_dft_seq_re, A_dft_seq_im, A_dft_hid_re, A_dft_hid_im)
    g = _silu(_B_ref(xn, B_w1, B_w2, B_w3, B_w4))
    return x + s * g
```

```asm
; @launch grid=(256,1,1) block=(512,1,1) lds=163840
.amdgcn_target "amdgcn-amd-amdhsa--gfx950"
.text
.globl recurrent_scan__spectral_fnet__mixer_s_mlp__prompt_kernel
.p2align 8
.type recurrent_scan__spectral_fnet__mixer_s_mlp__prompt_kernel,@function
recurrent_scan__spectral_fnet__mixer_s_mlp__prompt_kernel:
  s_cmp_ge_u32 s2, 256
  s_cbranch_scc1 LEND
  s_load_dwordx2 s[4:5], s[0:1], 0
  s_load_dwordx8 s[36:43], s[0:1], 48
  s_load_dwordx2 s[24:25], s[0:1], 80
  s_load_dwordx2 s[28:29], s[0:1], 96
  v_lshrrev_b32 v1, 6, v0
  v_and_b32 v0, 63, v0
  v_readfirstlane_b32 s51, v1
  s_and_b32 s3, s2, 7
  s_lshr_b32 s55, s2, 3
  s_and_b32 s49, s55, 7
  s_lshr_b32 s100, s55, 3
  s_lshl_b32 s48, s3, 2
  s_add_u32 s48, s48, s100
  s_lshr_b32 s3, s49, 2
  s_add_u32 s50, s3, 1
  s_sub_u32 s3, 0, s50
  s_bitcmp1_b32 s49, 1
  s_cselect_b32 s50, s3, s50
  s_mov_b32 s6, 0x200000
  s_mov_b32 s7, 0x20000
  s_mov_b32 s30, 0x1000000
  s_mov_b32 s31, 0x20000
  s_mov_b32 s26, 0x200000
  s_mov_b32 s27, 0x20000
  s_lshl_b32 s61, s48, 16
  s_lshl_b32 s3, s2, 1
  s_add_u32 s3, s3, s49
  s_bfe_u32 s46, s2, 0x10002
  s_add_u32 s3, s3, s46
  s_and_b32 s46, s3, 7
  s_and_b32 s33, s2, 7
  s_cmp_ge_u32 s51, 4
  s_cbranch_scc1 LA_START
  s_lshl_b32 s52, s51, 10
  s_lshl_b32 s3, s51, 3
  v_lshrrev_b32 v251, 3, v0
  v_add_u32 v245, s3, v251
  v_and_b32 v250, 7, v0
  v_bfe_u32 v249, v245, 1, 3
  v_xor_b32 v249, v250, v249
  v_lshlrev_b32 v249, 4, v249
  s_lshl_b32 s55, s48, 6
  s_sub_u32 s3, s55, s50
  v_add_u32 v248, s3, v245
  v_add_u32 v247, 32, v248
  v_and_b32 v248, 0x7ff, v248
  v_and_b32 v247, 0x7ff, v247
  v_lshl_add_u32 v255, v248, 10, v249
  v_lshl_add_u32 v254, v247, 10, v249
  s_lshl_b32 s56, s49, 7
  v_bfe_u32 v248, v245, 1, 1
  v_lshlrev_b32 v248, 2, v248
  v_xor_b32 v248, v248, v250
  v_lshlrev_b32 v248, 4, v248
  v_lshl_add_u32 v253, v245, 10, v248
  v_add_u32 v253, s56, v253
  s_waitcnt lgkmcnt(0)
  s_add_u32 s101, s33, 0
  s_and_b32 s101, s101, 7
  s_mul_i32 s101, s101, 0x80
  s_add_u32 m0, s52, 0x6000
s_nop 0
  buffer_load_dwordx4 v255, s[4:7], s101 offen nt lds
  s_add_u32 m0, s52, 0x7000
s_nop 0
  buffer_load_dwordx4 v254, s[4:7], s101 offen nt lds
  s_add_u32 s101, s33, 1
  s_and_b32 s101, s101, 7
  s_mul_i32 s101, s101, 0x80
  s_add_u32 m0, s52, 0xa000
s_nop 0
  buffer_load_dwordx4 v255, s[4:7], s101 offen nt lds
  s_add_u32 m0, s52, 0xb000
s_nop 0
  buffer_load_dwordx4 v254, s[4:7], s101 offen nt lds
  s_add_u32 s44, s28, 0xe22000
  s_addc_u32 s45, s29, 0
  s_load_dword s65, s[44:45], 0
  s_mov_b32 s8, s36
  s_mov_b32 s9, s37
  s_mov_b32 s10, 0x80000
  s_mov_b32 s11, 0x20000
  s_mov_b32 s12, s38
  s_mov_b32 s13, s39
  s_mov_b32 s14, 0x80000
  s_mov_b32 s15, 0x20000
  s_mov_b32 s16, s40
  s_mov_b32 s17, s41
  s_mov_b32 s18, 0x158000
  s_mov_b32 s19, 0x20000
  s_mov_b32 s20, s42
  s_mov_b32 s21, s43
  s_mov_b32 s22, 0x158000
  s_mov_b32 s23, 0x20000
  s_mul_i32 s62, s48, 0x2c000
  s_add_u32 s62, s62, 0x400000
  s_add_u32 s101, s33, 0
  s_and_b32 s101, s101, 7
  s_mul_i32 s101, s101, 0x10000
  s_add_u32 m0, s52, 0x10000
s_nop 0
  buffer_load_dwordx4 v253, s[8:11], s101 offen lds
  s_add_u32 m0, s52, 0x11000
  s_add_u32 s53, s101, 0x8000
  buffer_load_dwordx4 v253, s[8:11], s53 offen lds
  s_add_u32 s101, s33, 2
  s_and_b32 s101, s101, 7
  s_mul_i32 s101, s101, 0x80
  s_add_u32 m0, s52, 0xe000
s_nop 0
  buffer_load_dwordx4 v255, s[4:7], s101 offen nt lds
  s_add_u32 m0, s52, 0xf000
s_nop 0
  buffer_load_dwordx4 v254, s[4:7], s101 offen nt lds
  s_add_u32 s101, s33, 3
  s_and_b32 s101, s101, 7
  s_mul_i32 s101, s101, 0x80
  s_add_u32 m0, s52, 0x12000
s_nop 0
  buffer_load_dwordx4 v255, s[4:7], s101 offen nt lds
  s_add_u32 m0, s52, 0x13000
s_nop 0
  buffer_load_dwordx4 v254, s[4:7], s101 offen nt lds
  s_add_u32 s101, s33, 4
  s_and_b32 s101, s101, 7
  s_mul_i32 s101, s101, 0x80
  s_add_u32 m0, s52, 0x16000
s_nop 0
  buffer_load_dwordx4 v255, s[4:7], s101 offen nt lds
  s_add_u32 m0, s52, 0x17000
s_nop 0
  buffer_load_dwordx4 v254, s[4:7], s101 offen nt lds
  s_lshl_b32 s3, s49, 2
  s_add_u32 s3, s3, s51
  s_lshl_b32 s3, s3, 11
  s_add_u32 s3, s3, s61
  s_add_u32 s40, s4, s3
  s_addc_u32 s41, s5, 0
  s_add_u32 s101, s33, 5
  s_and_b32 s101, s101, 7
  s_mul_i32 s101, s101, 0x80
  s_add_u32 s44, s40, s101
  s_addc_u32 s45, s41, 0
  s_load_dword s0, s[44:45], 0x0
  s_load_dword s0, s[44:45], 0x40
  s_load_dword s0, s[44:45], 0x400
  s_load_dword s0, s[44:45], 0x440
  s_add_u32 s101, s33, 6
  s_and_b32 s101, s101, 7
  s_mul_i32 s101, s101, 0x80
  s_add_u32 s44, s40, s101
  s_addc_u32 s45, s41, 0
  s_load_dword s0, s[44:45], 0x0
  s_load_dword s0, s[44:45], 0x40
  s_load_dword s0, s[44:45], 0x400
  s_load_dword s0, s[44:45], 0x440
  s_add_u32 s101, s33, 7
  s_and_b32 s101, s101, 7
  s_mul_i32 s101, s101, 0x80
  s_add_u32 s44, s40, s101
  s_addc_u32 s45, s41, 0
  s_load_dword s0, s[44:45], 0x0
  s_load_dword s0, s[44:45], 0x40
  s_load_dword s0, s[44:45], 0x400
  s_load_dword s0, s[44:45], 0x440
  s_lshl_b32 s47, s46, 1
  s_mul_i32 s35, s49, 1
  s_and_b32 s3, s2, 7
  s_mul_i32 s3, s3, 21
  s_lshr_b32 s3, s3, 3
  s_add_u32 s35, s35, s3
  s_mul_i32 s3, s35, 0xc31
  s_lshr_b32 s3, s3, 16
  s_mul_i32 s3, s3, 21
  s_sub_u32 s35, s35, s3
  s_and_b32 s34, s100, 0
  s_lshl_b32 s1, s34, 12
  s_and_b32 s47, s2, 3
  s_lshl_b32 s47, s47, 1
  v_add_u32 v247, s55, v245
  v_lshl_add_u32 v241, v247, 10, v249
  v_add_u32 v241, s56, v241
  s_lshl_b32 s56, s48, 7
  v_mul_u32_u24 v240, 0x1080, v245
  v_add3_u32 v240, s56, v240, v248
  v_lshlrev_b32 v239, 2, v0
  v_lshlrev_b32 v238, 4, v0
  v_add_u32 v252, s52, v238
  v_and_b32 v237, 15, v0
  v_lshrrev_b32 v236, 4, v0
  s_mul_i32 s60, s51, 3072
  s_lshl_b32 s63, s48, 12
  s_add_u32 s63, s63, 0xe00000
  s_and_b32 s3, s51, 1
  s_lshl_b32 s3, s3, 5
  v_xor_b32 v244, s3, v253
  s_mul_i32 s58, s49, 5
  s_min_u32 s3, s49, 3
  s_add_u32 s58, s58, s3
  s_lshl_b32 s58, s58, 6
  v_mul_u32_u24 v247, 0xac0, v245
  v_add3_u32 v243, s58, v247, v248
  s_sub_u32 s3, s49, 3
  s_cmp_lt_u32 s3, 5
  s_cselect_b32 s3, 64, 0
  v_and_b32 v247, s3, v248
  v_lshl_or_b32 v242, v247, 24, v243
  s_lshl_b32 s64, s49, 5
  s_add_u32 s64, s64, s48
  s_add_u32 s64, s64, 1
  v_and_b32 v227, 28, v239
  v_and_b32 v226, 31, v0
  v_lshlrev_b32 v226, 7, v226
  v_lshlrev_b32 v224, 6, v0
  s_mov_b32 s54, 0
  s_lshl_b32 s3, s51, 4
  v_add_u32 v230, s3, v237
  v_cvt_f32_u32 v230, v230
  v_cvt_f32_u32 v229, v236
  v_mul_f32 v234, 0x3c800000, v230
  v_mul_f32 v233, 0x3ec80000, v230
  v_mul_f32 v235, 0x41000000, v229
  v_mul_f32 v235, v235, v234
  v_cos_f32 v232, v235
  v_add_f32 v235, v235, v234
  v_cos_f32 v231, v235
  v_add_f32 v235, v235, v234
  v_cvt_pk_bf16_f32 v4, v232, v231
  v_cos_f32 v232, v235
  v_add_f32 v235, v235, v234
  v_cos_f32 v231, v235
  v_add_f32 v235, v235, v234
  v_cvt_pk_bf16_f32 v5, v232, v231
  v_cos_f32 v232, v235
  v_add_f32 v235, v235, v234
  v_cos_f32 v231, v235
  v_add_f32 v235, v235, v234
  v_cvt_pk_bf16_f32 v6, v232, v231
  v_cos_f32 v232, v235
  v_add_f32 v235, v235, v234
  v_cos_f32 v231, v235
  v_add_f32 v235, v235, v233
  v_cvt_pk_bf16_f32 v7, v232, v231
  v_cos_f32 v232, v235
  v_add_f32 v235, v235, v234
  v_cos_f32 v231, v235
  v_add_f32 v235, v235, v234
  v_cvt_pk_bf16_f32 v8, v232, v231
  s_waitcnt vmcnt(8)
  s_barrier
  s_add_u32 s101, s33, 1
  s_and_b32 s101, s101, 7
  s_mul_i32 s101, s101, 0x10000
  s_add_u32 m0, s52, 0x14000
s_nop 0
  buffer_load_dwordx4 v253, s[8:11], s101 offen lds
  s_add_u32 m0, s52, 0x15000
  s_add_u32 s53, s101, 0x8000
  buffer_load_dwordx4 v253, s[8:11], s53 offen lds
  s_add_u32 s101, s33, 5
  s_and_b32 s101, s101, 7
  s_mul_i32 s101, s101, 0x80
  s_add_u32 m0, s52, 0x1a000
s_nop 0
  buffer_load_dwordx4 v255, s[4:7], s101 offen lds
  s_add_u32 m0, s52, 0x1b000
s_nop 0
  buffer_load_dwordx4 v254, s[4:7], s101 offen lds
  s_waitcnt vmcnt(10)
  s_barrier
  s_add_u32 s101, s33, 2
  s_and_b32 s101, s101, 7
  s_mul_i32 s101, s101, 0x10000
  s_add_u32 m0, s52, 0x18000
s_nop 0
  buffer_load_dwordx4 v253, s[8:11], s101 offen lds
  s_add_u32 m0, s52, 0x19000
  s_add_u32 s53, s101, 0x8000
  buffer_load_dwordx4 v253, s[8:11], s53 offen lds
  s_waitcnt vmcnt(8)
  s_barrier
  s_add_u32 s101, s33, 6
  s_and_b32 s101, s101, 7
  s_mul_i32 s101, s101, 0x80
  s_add_u32 m0, s52, 0x1e000
s_nop 0
  buffer_load_dwordx4 v255, s[4:7], s101 offen lds
  s_add_u32 m0, s52, 0x1f000
s_nop 0
  buffer_load_dwordx4 v254, s[4:7], s101 offen lds
  s_add_u32 s101, s33, 7
  s_and_b32 s101, s101, 7
  s_mul_i32 s101, s101, 0x80
  s_add_u32 m0, s52, 0x20000
s_nop 0
  buffer_load_dwordx4 v255, s[4:7], s101 offen lds
  s_add_u32 m0, s52, 0x21000
s_nop 0
  buffer_load_dwordx4 v254, s[4:7], s101 offen lds
  s_waitcnt vmcnt(8)
  s_barrier
  s_add_u32 s101, s33, 3
  s_and_b32 s101, s101, 7
  s_mul_i32 s101, s101, 0x10000
  s_add_u32 m0, s52, 0x1c000
s_nop 0
  buffer_load_dwordx4 v253, s[8:11], s101 offen lds
  s_add_u32 m0, s52, 0x1d000
  s_add_u32 s53, s101, 0x8000
  buffer_load_dwordx4 v253, s[8:11], s53 offen lds
  s_lshl_b32 s3, s2, 2
  s_add_u32 s3, s3, s51
  s_mul_i32 s3, s3, 512
  s_min_u32 s3, s3, 0x7fe00
  s_add_u32 s44, s12, s3
  s_addc_u32 s45, s13, 0
  s_load_dword s0, s[44:45], 0x0
  s_load_dword s0, s[44:45], 0x40
  s_load_dword s0, s[44:45], 0x80
  s_load_dword s0, s[44:45], 0xc0
  s_load_dword s0, s[44:45], 0x100
  s_load_dword s0, s[44:45], 0x140
  s_load_dword s0, s[44:45], 0x180
  s_load_dword s0, s[44:45], 0x1c0
  s_lshl_b32 s3, s2, 2
  s_add_u32 s3, s3, s51
  s_mul_i32 s3, s3, 1408
  s_min_u32 s3, s3, 0x157a80
  s_add_u32 s44, s16, s3
  s_addc_u32 s45, s17, 0
  s_load_dword s0, s[44:45], 0x0
  s_load_dword s0, s[44:45], 0x40
  s_load_dword s0, s[44:45], 0x80
  s_load_dword s0, s[44:45], 0xc0
  s_load_dword s0, s[44:45], 0x100
  s_waitcnt vmcnt(8)
  s_barrier
  s_add_u32 s101, s33, 4
  s_and_b32 s101, s101, 7
  s_mul_i32 s101, s101, 0x10000
  s_add_u32 m0, s52, 0x22000
s_nop 0
  buffer_load_dwordx4 v253, s[8:11], s101 offen lds
  s_add_u32 m0, s52, 0x23000
  s_add_u32 s53, s101, 0x8000
  buffer_load_dwordx4 v253, s[8:11], s53 offen lds
  s_add_u32 s101, s33, 5
  s_and_b32 s101, s101, 7
  s_mul_i32 s101, s101, 0x10000
  s_add_u32 m0, s52, 0x24000
s_nop 0
  buffer_load_dwordx4 v253, s[8:11], s101 offen lds
  s_add_u32 m0, s52, 0x25000
  s_add_u32 s53, s101, 0x8000
  buffer_load_dwordx4 v253, s[8:11], s53 offen lds
  s_waitcnt vmcnt(10)
  s_barrier
  s_add_u32 s101, s33, 6
  s_and_b32 s101, s101, 7
  s_mul_i32 s101, s101, 0x10000
  s_add_u32 m0, s52, 0x0
s_nop 0
  buffer_load_dwordx4 v253, s[8:11], s101 offen lds
  s_add_u32 m0, s52, 0x1000
  s_add_u32 s53, s101, 0x8000
  buffer_load_dwordx4 v253, s[8:11], s53 offen lds
  s_waitcnt vmcnt(8)
  s_barrier
  s_add_u32 s101, s33, 7
  s_and_b32 s101, s101, 7
  s_mul_i32 s101, s101, 0x10000
  s_add_u32 m0, s52, 0x2000
s_nop 0
  buffer_load_dwordx4 v253, s[8:11], s101 offen lds
  s_add_u32 m0, s52, 0x3000
  s_add_u32 s53, s101, 0x8000
  buffer_load_dwordx4 v253, s[8:11], s53 offen lds
  s_add_u32 m0, s52, 0x4000
s_nop 0
  buffer_load_dwordx4 v241, s[4:7], 0 offen lds
  s_add_u32 m0, s52, 0x5000
  s_mov_b32 s53, 0x8000
  buffer_load_dwordx4 v241, s[4:7], s53 offen lds
  s_waitcnt vmcnt(10)
  s_barrier
  s_add_u32 s101, s46, 0
  s_and_b32 s101, s101, 7
  s_mul_i32 s101, s101, 0x10000
  s_add_u32 m0, s52, 0x8000
s_nop 0
  buffer_load_dwordx4 v253, s[12:15], s101 offen lds
  s_add_u32 m0, s52, 0x9000
  s_add_u32 s53, s101, 0x8000
  buffer_load_dwordx4 v253, s[12:15], s53 offen lds
  s_waitcnt vmcnt(10)
  s_barrier
  s_add_u32 s101, s46, 1
  s_and_b32 s101, s101, 7
  s_mul_i32 s101, s101, 0x10000
  s_add_u32 m0, s52, 0xc000
s_nop 0
  buffer_load_dwordx4 v253, s[12:15], s101 offen lds
  s_add_u32 m0, s52, 0xd000
  s_add_u32 s53, s101, 0x8000
  buffer_load_dwordx4 v253, s[12:15], s53 offen lds
  s_waitcnt vmcnt(10)
  s_barrier
  s_add_u32 s101, s46, 2
  s_and_b32 s101, s101, 7
  s_mul_i32 s101, s101, 0x10000
  s_add_u32 m0, s52, 0x10000
s_nop 0
  buffer_load_dwordx4 v253, s[12:15], s101 offen lds
  s_add_u32 m0, s52, 0x11000
  s_add_u32 s53, s101, 0x8000
  buffer_load_dwordx4 v253, s[12:15], s53 offen lds
  s_waitcnt lgkmcnt(0)
  s_add_u32 s65, s65, 0x9e3779b9
  s_cmp_lg_u32 s51, 0
  s_cbranch_scc1 Lw_1
  s_getreg_b32 s54, hwreg(HW_REG_XCC_ID, 0, 4)
  s_add_u32 s43, s65, 16
  s_add_u32 s3, s54, s43
  v_mov_b32 v228, s3
  buffer_load_dword v226, v226, s[28:31], s63 offen sc1
  v_and_b32 v227, 28, v239
  s_lshl_b32 s3, s49, 2
  s_add_u32 s3, s3, s63
  s_mov_b64 exec, 1
  buffer_store_dword v228, off, s[28:31], s3 offset:3072 sc1
  s_mov_b64 exec, -1
Lw_1:
  s_waitcnt vmcnt(10)
  s_barrier
  s_add_u32 s101, s46, 3
  s_and_b32 s101, s101, 7
  s_mul_i32 s101, s101, 0x10000
  s_add_u32 m0, s52, 0x14000
s_nop 0
  buffer_load_dwordx4 v253, s[12:15], s101 offen lds
  s_add_u32 m0, s52, 0x15000
  s_add_u32 s53, s101, 0x8000
  buffer_load_dwordx4 v253, s[12:15], s53 offen lds
  s_waitcnt vmcnt(10)
  s_barrier
  s_add_u32 s101, s46, 4
  s_and_b32 s101, s101, 7
  s_mul_i32 s101, s101, 0x10000
  s_add_u32 m0, s52, 0x18000
s_nop 0
  buffer_load_dwordx4 v253, s[12:15], s101 offen lds
  s_add_u32 m0, s52, 0x19000
  s_add_u32 s53, s101, 0x8000
  buffer_load_dwordx4 v253, s[12:15], s53 offen lds
  s_lshl_b32 s3, s2, 2
  s_add_u32 s3, s3, s51
  s_mul_i32 s3, s3, 1408
  s_min_u32 s3, s3, 0x157a80
  s_add_u32 s44, s16, s3
  s_addc_u32 s45, s17, 0
  s_load_dword s0, s[44:45], 0x140
  s_load_dword s0, s[44:45], 0x180
  s_load_dword s0, s[44:45], 0x1c0
  s_load_dword s0, s[44:45], 0x200
  s_load_dword s0, s[44:45], 0x240
  s_load_dword s0, s[44:45], 0x280
  s_load_dword s0, s[44:45], 0x2c0
  s_load_dword s0, s[44:45], 0x300
  s_load_dword s0, s[44:45], 0x340
  s_load_dword s0, s[44:45], 0x380
  s_load_dword s0, s[44:45], 0x3c0
  s_load_dword s0, s[44:45], 0x400
  s_load_dword s0, s[44:45], 0x440
  s_cmp_lg_u32 s51, 0
  s_cbranch_scc1 Lw_2
  buffer_load_dword v228, v227, s[28:31], s63 offen offset:3072 sc1
Lw_2:
  s_waitcnt vmcnt(10)
  s_barrier
  s_add_u32 s101, s46, 5
  s_and_b32 s101, s101, 7
  s_mul_i32 s101, s101, 0x10000
  s_add_u32 m0, s52, 0x1c000
s_nop 0
  buffer_load_dwordx4 v253, s[12:15], s101 offen lds
  s_add_u32 m0, s52, 0x1d000
  s_add_u32 s53, s101, 0x8000
  buffer_load_dwordx4 v253, s[12:15], s53 offen lds
  s_add_u32 s101, s46, 6
  s_and_b32 s101, s101, 7
  s_mul_i32 s101, s101, 0x10000
  s_add_u32 m0, s52, 0x22000
s_nop 0
  buffer_load_dwordx4 v253, s[12:15], s101 offen lds
  s_add_u32 m0, s52, 0x23000
  s_add_u32 s53, s101, 0x8000
  buffer_load_dwordx4 v253, s[12:15], s53 offen lds
  s_add_u32 s101, s46, 7
  s_and_b32 s101, s101, 7
  s_mul_i32 s101, s101, 0x10000
  s_add_u32 m0, s52, 0x24000
s_nop 0
  buffer_load_dwordx4 v253, s[12:15], s101 offen lds
  s_add_u32 m0, s52, 0x25000
  s_add_u32 s53, s101, 0x8000
  buffer_load_dwordx4 v253, s[12:15], s53 offen lds
  s_mov_b32 s101, s49
  s_mul_i32 s101, s101, 0x2b000
  s_add_u32 m0, s52, 0x0
s_nop 0
  buffer_load_dwordx4 v243, s[16:19], s101 offen lds
  s_add_u32 m0, s52, 0x1000
  s_add_u32 s53, s101, 0x80
  buffer_load_dwordx4 v243, s[16:19], s53 offen lds
  s_add_u32 m0, s52, 0x2000
  s_add_u32 s53, s101, 0x100
  buffer_load_dwordx4 v242, s[16:19], s53 offen lds
  s_cmp_lg_u32 s51, 0
  s_cbranch_scc1 Lw_3
  s_waitcnt vmcnt(9)
  v_subrev_u32 v246, s43, v228
  v_cmp_gt_u32 vcc, 16, v246
s_nop 0
  s_cmp_eq_u64 vcc, exec
  s_cbranch_scc1 Lok_4
  s_mov_b32 s59, 0
Lpoll_5:
  buffer_load_dword v228, v227, s[28:31], s63 offen offset:3072 sc1
  s_waitcnt vmcnt(0)
  v_subrev_u32 v246, s43, v228
  v_cmp_gt_u32 vcc, 16, v246
  s_add_u32 s59, s59, 1
  s_cmp_eq_u64 vcc, exec
  s_cbranch_scc1 Lpollok_6
  s_cmp_lt_u32 s59, 0x40000
  s_cbranch_scc1 Lpoll_5
Lpollok_6:
Lok_4:
  v_cmp_eq_u32 vcc, s54, v246
s_nop 0
  s_cmp_eq_u64 vcc, exec
  s_cselect_b32 s54, 1, 0
Lw_3:
  v_bfe_u32 v248, v0, 2, 2
  v_lshl_add_u32 v248, v236, 3, v248
  v_and_b32 v247, 3, v0
  v_lshlrev_b32 v247, 3, v247
  v_lshl_add_u32 v220, v248, 6, v247
  v_add_u32 v220, 0x18000, v220
  s_lshl_b32 s3, s51, 1
  v_lshrrev_b32 v248, 1, v236
  v_add_u32 v248, s3, v248
  v_and_b32 v247, 7, v237
  v_xor_b32 v248, v248, v247
  v_lshlrev_b32 v248, 4, v248
  v_lshl_add_u32 v248, v237, 7, v248
  v_and_b32 v247, 1, v236
  v_lshl_add_u32 v248, v247, 3, v248
  v_add_u32 v219, 0x10000, v248
  s_and_b32 s42, s51, 1
  s_lshl_b32 s3, s42, 7
  v_add_u32 v248, s3, v0
  v_sub_u32 v247, 0xbf, v248
  v_add_u32 v251, 1, v247
  s_cmp_lt_u32 s51, 2
  s_cselect_b64 vcc, -1, 0
  v_cndmask_b32 v248, v247, v248, vcc
  v_bfe_u32 v247, v248, 3, 3
  v_xor_b32 v247, v247, v248
  v_lshlrev_b32 v247, 4, v247
  v_add_u32 v218, 0x10000, v247
  v_bfe_u32 v247, v251, 3, 3
  v_xor_b32 v247, v247, v251
  v_lshlrev_b32 v247, 4, v247
  v_add_u32 v217, 0x10000, v247
  v_add_u32 v251, 64, v251
  v_and_b32 v251, 0xff, v251
  v_bfe_u32 v247, v251, 3, 3
  v_xor_b32 v247, v247, v251
  v_lshlrev_b32 v247, 4, v247
  v_add_u32 v216, 0x10000, v247
  s_sub_u32 s3, 512, s64
  s_and_b32 s3, s3, 0x1ff
  s_cmp_eq_u32 s64, 256
  s_cselect_b32 s3, 0, s3
  s_cmp_lt_u32 s51, 2
  s_cselect_b32 s57, s64, s3
  v_cos_f32 v232, v235
  v_add_f32 v235, v235, v234
  v_cos_f32 v231, v235
  v_add_f32 v235, v235, v234
  v_cvt_pk_bf16_f32 v9, v232, v231
  v_cos_f32 v232, v235
  v_add_f32 v235, v235, v234
  v_cos_f32 v231, v235
  v_add_f32 v235, v235, v234
  v_cvt_pk_bf16_f32 v10, v232, v231
  v_cos_f32 v232, v235
  v_add_f32 v235, v235, v234
  v_cos_f32 v231, v235
  v_add_f32 v235, v235, v233
  v_cvt_pk_bf16_f32 v11, v232, v231
  v_mul_f32 v235, 0x41000000, v229
  v_mul_f32 v235, v235, v234
  v_sin_f32 v232, v235
  v_add_f32 v235, v235, v234
  v_sin_f32 v231, v235
  v_add_f32 v235, v235, v234
  v_cvt_pk_bf16_f32 v12, v232, v231
  v_sin_f32 v232, v235
  v_add_f32 v235, v235, v234
  v_sin_f32 v231, v235
  v_add_f32 v235, v235, v234
  v_cvt_pk_bf16_f32 v13, v232, v231
  v_sin_f32 v232, v235
  v_add_f32 v235, v235, v234
  v_sin_f32 v231, v235
  v_add_f32 v235, v235, v234
  v_cvt_pk_bf16_f32 v14, v232, v231
  v_sin_f32 v232, v235
  v_add_f32 v235, v235, v234
  v_sin_f32 v231, v235
  v_add_f32 v235, v235, v233
  v_cvt_pk_bf16_f32 v15, v232, v231
  v_sin_f32 v232, v235
  v_add_f32 v235, v235, v234
  v_sin_f32 v231, v235
  v_add_f32 v235, v235, v234
  v_cvt_pk_bf16_f32 v16, v232, v231
  v_sin_f32 v232, v235
  v_add_f32 v235, v235, v234
  v_sin_f32 v231, v235
  v_add_f32 v235, v235, v234
  v_cvt_pk_bf16_f32 v17, v232, v231
  v_sin_f32 v232, v235
  v_add_f32 v235, v235, v234
  v_sin_f32 v231, v235
  v_add_f32 v235, v235, v234
  v_cvt_pk_bf16_f32 v18, v232, v231
  v_sin_f32 v232, v235
  v_add_f32 v235, v235, v234
  v_add_u32 v215, 0x10000, v252
  s_add_u32 s32, s65, 1
  v_mov_b32 v228, s32
  s_lshl_b32 s41, s49, 2
  s_add_u32 s41, s41, s63
  s_lshl_b32 s40, s49, 13
  s_add_u32 s40, s40, s61
  s_add_u32 s40, s40, 0x0
  v_lshlrev_b32 v222, 7, v0
  s_cmp_eq_u32 s51, 0
  s_cselect_b64 exec, 0xffff, -1
  s_cselect_b32 s3, s54, 0
  s_cmp_lg_u32 s3, 0
  s_barrier
  s_cbranch_scc0 Lother_7
  buffer_store_dword v228, v224, s[28:31], s41 offen offset:0
  s_branch Ljoin_8
Lother_7:
  s_cmp_lg_u32 s51, 0
  s_cbranch_scc1 Lskip_9
  buffer_store_dword v228, v224, s[28:31], s41 offen offset:0 sc1
Ljoin_8:
  s_mov_b64 exec, -1
  buffer_load_dword v221, v222, s[28:31], s40 offen sc1
Lskip_9:
  s_add_u32 s101, s47, 3
  s_sub_u32 s3, s101, 7
  s_cselect_b32 s101, s101, s3
  s_add_u32 s101, s101, s49
  s_add_u32 s101, s101, 1
  s_and_b32 s101, s101, 7
  s_mul_i32 s101, s101, 0x2b000
  buffer_load_dwordx4 v[84:87], v243, s[16:19], s101 offen
  s_add_u32 s101, s101, 128
  buffer_load_dwordx4 v[88:91], v243, s[16:19], s101 offen
  s_add_u32 s101, s101, 128
  buffer_load_dwordx4 v[92:95], v242, s[16:19], s101 offen
  s_add_u32 s101, s47, 3
  s_sub_u32 s3, s101, 7
  s_cselect_b32 s101, s101, s3
  s_add_u32 s101, s101, s49
  s_add_u32 s101, s101, 1
  s_and_b32 s101, s101, 7
  s_mul_i32 s101, s101, 0x2b000
  s_add_u32 s101, s101, 0x15800
  buffer_load_dwordx4 v[96:99], v243, s[16:19], s101 offen
  s_add_u32 s101, s101, 128
  buffer_load_dwordx4 v[100:103], v243, s[16:19], s101 offen
  s_add_u32 s101, s101, 128
  buffer_load_dwordx4 v[104:107], v242, s[16:19], s101 offen
  v_sin_f32 v231, v235
  v_add_f32 v235, v235, v233
  v_cvt_pk_bf16_f32 v19, v232, v231
  v_xor_b32 v20, 0x80008000, v12
  v_xor_b32 v21, 0x80008000, v13
  v_xor_b32 v22, 0x80008000, v14
  v_xor_b32 v23, 0x80008000, v15
  v_xor_b32 v24, 0x80008000, v16
  v_xor_b32 v25, 0x80008000, v17
  v_xor_b32 v26, 0x80008000, v18
  v_xor_b32 v27, 0x80008000, v19
  v_cvt_f32_i32 v232, s50
  v_mul_f32 v229, 4.0, v229
  v_sub_f32 v229, v229, v232
  v_mul_f32 v234, 0x3a000000, v230
  v_mul_f32 v233, 0x3bd00000, v230
  v_mul_f32 v235, v229, v234
  v_cos_f32 v28, v235
  v_sin_f32 v36, v235
  v_add_f32 v235, v235, v234
  v_cos_f32 v29, v235
  v_sin_f32 v37, v235
  v_add_f32 v235, v235, v234
  v_cos_f32 v30, v235
  v_sin_f32 v38, v235
  v_add_f32 v235, v235, v234
  v_cos_f32 v31, v235
  v_sin_f32 v39, v235
  v_add_f32 v235, v235, v233
  v_cos_f32 v32, v235
  v_sin_f32 v40, v235
  v_add_f32 v235, v235, v234
  v_cos_f32 v33, v235
  v_sin_f32 v41, v235
  v_add_f32 v235, v235, v234
  v_cos_f32 v34, v235
  v_sin_f32 v42, v235
  v_add_f32 v235, v235, v234
  v_cos_f32 v35, v235
  v_sin_f32 v43, v235
  v_add_f32 v235, v235, v234
  v_add_u32 v230, 0, v237
  v_cvt_f32_u32 v230, v230
  v_mul_f32 v234, 0x3d000000, v230
  v_mul_f32 v233, 0x3ed00000, v230
  v_mul_f32 v235, v229, v234
  v_cos_f32 v232, v235
  v_add_f32 v235, v235, v234
  v_cos_f32 v231, v235
  v_add_f32 v235, v235, v234
  v_cvt_pk_bf16_f32 v44, v232, v231
  v_cos_f32 v232, v235
  v_add_f32 v235, v235, v234
  v_cos_f32 v231, v235
  v_add_f32 v235, v235, v233
  v_cvt_pk_bf16_f32 v45, v232, v231
  v_cos_f32 v232, v235
  v_add_f32 v235, v235, v234
  s_barrier
  s_add_u32 s101, s46, 0
  s_and_b32 s101, s101, 7
  s_mul_i32 s101, s101, 0x2000
  s_add_u32 s101, s101, s61
  s_add_u32 m0, s52, 0x6000
s_nop 0
  buffer_load_dwordx4 v252, s[28:31], s101 offen sc1 lds
  s_add_u32 m0, s52, 0x7000
  s_add_u32 s53, s101, 0x1000
  buffer_load_dwordx4 v252, s[28:31], s53 offen sc1 lds
  s_add_u32 s101, s46, 1
  s_and_b32 s101, s101, 7
  s_mul_i32 s101, s101, 0x2000
  s_add_u32 s101, s101, s61
  s_add_u32 m0, s52, 0xa000
s_nop 0
  buffer_load_dwordx4 v252, s[28:31], s101 offen sc1 lds
  s_add_u32 m0, s52, 0xb000
  s_add_u32 s53, s101, 0x1000
  buffer_load_dwordx4 v252, s[28:31], s53 offen sc1 lds
  s_add_u32 s101, s46, 2
  s_and_b32 s101, s101, 7
  s_mul_i32 s101, s101, 0x2000
  s_add_u32 s101, s101, s61
  s_add_u32 m0, s52, 0xe000
s_nop 0
  buffer_load_dwordx4 v252, s[28:31], s101 offen sc1 lds
  s_add_u32 m0, s52, 0xf000
  s_add_u32 s53, s101, 0x1000
  buffer_load_dwordx4 v252, s[28:31], s53 offen sc1 lds
  s_add_u32 s101, s46, 3
  s_and_b32 s101, s101, 7
  s_mul_i32 s101, s101, 0x2000
  s_add_u32 s101, s101, s61
  s_add_u32 m0, s52, 0x12000
s_nop 0
  buffer_load_dwordx4 v252, s[28:31], s101 offen sc1 lds
  s_add_u32 m0, s52, 0x13000
  s_add_u32 s53, s101, 0x1000
  buffer_load_dwordx4 v252, s[28:31], s53 offen sc1 lds
  s_waitcnt vmcnt(6)
  s_barrier
  s_add_u32 s101, s46, 4
  s_and_b32 s101, s101, 7
  s_mul_i32 s101, s101, 0x2000
  s_add_u32 s101, s101, s61
  s_add_u32 m0, s52, 0x16000
s_nop 0
  buffer_load_dwordx4 v252, s[28:31], s101 offen sc1 lds
  s_add_u32 m0, s52, 0x17000
  s_add_u32 s53, s101, 0x1000
  buffer_load_dwordx4 v252, s[28:31], s53 offen sc1 lds
  s_lshl_b32 s3, s2, 2
  s_add_u32 s3, s3, s51
  s_mul_i32 s3, s3, 1408
  s_min_u32 s3, s3, 0x157a80
  s_add_u32 s44, s16, s3
  s_addc_u32 s45, s17, 0
  s_load_dword s0, s[44:45], 0x480
  s_load_dword s0, s[44:45], 0x4c0
  s_load_dword s0, s[44:45], 0x500
  s_load_dword s0, s[44:45], 0x540
  s_lshl_b32 s3, s2, 2
  s_add_u32 s3, s3, s51
  s_mul_i32 s3, s3, 1408
  s_min_u32 s3, s3, 0x157a80
  s_add_u32 s44, s20, s3
  s_addc_u32 s45, s21, 0
  s_load_dword s0, s[44:45], 0x0
  s_load_dword s0, s[44:45], 0x40
  s_load_dword s0, s[44:45], 0x80
  s_load_dword s0, s[44:45], 0xc0
  s_load_dword s0, s[44:45], 0x100
  s_load_dword s0, s[44:45], 0x140
  s_load_dword s0, s[44:45], 0x180
  s_load_dword s0, s[44:45], 0x1c0
  s_load_dword s0, s[44:45], 0x200
  s_load_dword s0, s[44:45], 0x240
  s_waitcnt vmcnt(6)
  s_barrier
  s_add_u32 s101, s46, 5
  s_and_b32 s101, s101, 7
  s_mul_i32 s101, s101, 0x2000
  s_add_u32 s101, s101, s61
  s_add_u32 m0, s52, 0x1a000
s_nop 0
  buffer_load_dwordx4 v252, s[28:31], s101 offen sc1 lds
  s_add_u32 m0, s52, 0x1b000
  s_add_u32 s53, s101, 0x1000
  buffer_load_dwordx4 v252, s[28:31], s53 offen sc1 lds
  s_waitcnt vmcnt(6)
  s_barrier
  s_add_u32 s101, s46, 6
  s_and_b32 s101, s101, 7
  s_mul_i32 s101, s101, 0x2000
  s_add_u32 s101, s101, s61
  s_add_u32 m0, s52, 0x1e000
s_nop 0
  buffer_load_dwordx4 v252, s[28:31], s101 offen sc1 lds
  s_add_u32 m0, s52, 0x1f000
  s_add_u32 s53, s101, 0x1000
  buffer_load_dwordx4 v252, s[28:31], s53 offen sc1 lds
  s_waitcnt vmcnt(6)
  s_barrier
  s_add_u32 s101, s46, 7
  s_and_b32 s101, s101, 7
  s_mul_i32 s101, s101, 0x2000
  s_add_u32 s101, s101, s61
  s_add_u32 m0, s52, 0x20000
s_nop 0
  buffer_load_dwordx4 v252, s[28:31], s101 offen sc1 lds
  s_add_u32 m0, s52, 0x21000
  s_add_u32 s53, s101, 0x1000
  buffer_load_dwordx4 v252, s[28:31], s53 offen sc1 lds
  s_waitcnt vmcnt(6)
  s_barrier
  s_cmp_lg_u32 s51, 2
  s_cbranch_scc1 Lw_10
  v_and_b32 v223, 7, v0
  v_lshlrev_b32 v223, 7, v223
  buffer_load_dword v223, v223, s[28:31], s63 offen offset:1024 sc1
Lw_10:
  s_waitcnt vmcnt(4)
  s_barrier
  s_mov_b32 s101, s49
  s_mul_i32 s101, s101, 0x2b000
  s_add_u32 s101, s101, 0x15800
  s_add_u32 m0, s52, 0x3000
s_nop 0
  buffer_load_dwordx4 v243, s[16:19], s101 offen lds
  s_add_u32 m0, s52, 0x4000
  s_add_u32 s53, s101, 0x80
  buffer_load_dwordx4 v243, s[16:19], s53 offen lds
  s_add_u32 m0, s52, 0x5000
  s_add_u32 s53, s101, 0x100
  buffer_load_dwordx4 v242, s[16:19], s53 offen lds
  s_waitcnt vmcnt(5)
  s_waitcnt vmcnt(3)
  s_barrier
  s_add_u32 s101, s47, 0
  s_sub_u32 s3, s101, 7
  s_cselect_b32 s101, s101, s3
  s_add_u32 s101, s101, s49
  s_add_u32 s101, s101, 1
  s_and_b32 s101, s101, 7
  s_mul_i32 s101, s101, 0x2b000
  s_add_u32 m0, s52, 0x6000
s_nop 0
  buffer_load_dwordx4 v243, s[16:19], s101 offen lds
  s_add_u32 m0, s52, 0x7000
  s_add_u32 s53, s101, 0x80
  buffer_load_dwordx4 v243, s[16:19], s53 offen lds
  s_add_u32 m0, s52, 0x8000
  s_add_u32 s53, s101, 0x100
  buffer_load_dwordx4 v242, s[16:19], s53 offen lds
  s_add_u32 s101, s47, 0
  s_sub_u32 s3, s101, 7
  s_cselect_b32 s101, s101, s3
  s_add_u32 s101, s101, s49
  s_add_u32 s101, s101, 1
  s_and_b32 s101, s101, 7
  s_mul_i32 s101, s101, 0x2b000
  s_add_u32 s101, s101, 0x15800
  s_add_u32 m0, s52, 0x9000
s_nop 0
  buffer_load_dwordx4 v243, s[16:19], s101 offen lds
  s_add_u32 m0, s52, 0xa000
  s_add_u32 s53, s101, 0x80
  buffer_load_dwordx4 v243, s[16:19], s53 offen lds
  s_add_u32 m0, s52, 0xb000
  s_add_u32 s53, s101, 0x100
  buffer_load_dwordx4 v242, s[16:19], s53 offen lds
  s_add_u32 s101, s47, 1
  s_sub_u32 s3, s101, 7
  s_cselect_b32 s101, s101, s3
  s_add_u32 s101, s101, s49
  s_add_u32 s101, s101, 1
  s_and_b32 s101, s101, 7
  s_mul_i32 s101, s101, 0x2b000
  s_add_u32 m0, s52, 0xc000
s_nop 0
  buffer_load_dwordx4 v243, s[16:19], s101 offen lds
  s_add_u32 m0, s52, 0xd000
  s_add_u32 s53, s101, 0x80
  buffer_load_dwordx4 v243, s[16:19], s53 offen lds
  s_add_u32 m0, s52, 0xe000
  s_add_u32 s53, s101, 0x100
  buffer_load_dwordx4 v242, s[16:19], s53 offen lds
  v_bfe_u32 v248, v0, 2, 2
  v_lshrrev_b32 v247, 5, v0
  v_lshl_add_u32 v248, v247, 2, v248
  v_lshl_add_u32 v248, v248, 7, s52
  v_bfe_u32 v247, v0, 4, 1
  v_and_b32 v246, 1, v0
  v_lshl_add_u32 v247, v247, 1, v246
  v_lshl_add_u32 v248, v247, 4, v248
  v_bfe_u32 v247, v0, 1, 1
  v_lshl_add_u32 v248, v247, 3, v248
  v_bfe_u32 v247, v0, 3, 1
  v_lshl_add_u32 v213, v247, 6, v248
  v_xor_b32 v212, 64, v213
  v_mov_b32 v214, 0x3f803f80
  s_and_b32 s3, s2, 3
  s_cmp_eq_u32 s3, 3
  s_cselect_b32 s3, 0, 0x6000
  v_add_u32 v213, s3, v213
  v_add_u32 v212, s3, v212
  v_mov_b32 v140, 0
  v_mov_b32 v141, 0
  v_mov_b32 v142, 0
  v_mov_b32 v143, 0
  v_mov_b32 v144, 0
  v_mov_b32 v145, 0
  s_barrier
  s_add_u32 s101, s47, 1
  s_sub_u32 s3, s101, 7
  s_cselect_b32 s101, s101, s3
  s_add_u32 s101, s101, s49
  s_add_u32 s101, s101, 1
  s_and_b32 s101, s101, 7
  s_mul_i32 s101, s101, 0x2b000
  s_add_u32 s101, s101, 0x15800
  s_add_u32 m0, s52, 0xf000
s_nop 0
  buffer_load_dwordx4 v243, s[16:19], s101 offen lds
  s_add_u32 m0, s52, 0x10000
  s_add_u32 s53, s101, 0x80
  buffer_load_dwordx4 v243, s[16:19], s53 offen lds
  s_add_u32 m0, s52, 0x11000
  s_add_u32 s53, s101, 0x100
  buffer_load_dwordx4 v242, s[16:19], s53 offen lds
  ds_write_b128 v215, v[84:87] offset:32768
  ds_write_b128 v215, v[88:91] offset:36864
  ds_write_b128 v215, v[92:95] offset:40960
  ds_write_b128 v215, v[96:99] offset:45056
  ds_write_b128 v215, v[100:103] offset:49152
  ds_write_b128 v215, v[104:107] offset:53248
  s_waitcnt vmcnt(6)
  ds_read_b64_tr_b16 v[108:109], v213 offset:0
  ds_read_b64_tr_b16 v[110:111], v212 offset:0
  ds_read_b64_tr_b16 v[112:113], v213 offset:4096
  ds_read_b64_tr_b16 v[114:115], v212 offset:4096
  ds_read_b64_tr_b16 v[116:117], v213 offset:8192
  ds_read_b64_tr_b16 v[118:119], v212 offset:8192
  ds_read_b64_tr_b16 v[120:121], v213 offset:12288
  ds_read_b64_tr_b16 v[122:123], v212 offset:12288
  ds_read_b64_tr_b16 v[124:125], v213 offset:16384
  ds_read_b64_tr_b16 v[126:127], v212 offset:16384
  ds_read_b64_tr_b16 v[128:129], v213 offset:20480
  ds_read_b64_tr_b16 v[130:131], v212 offset:20480
  s_waitcnt lgkmcnt(0)
  v_dot2c_f32_bf16 v140, v214, v108
  v_dot2c_f32_bf16 v141, v214, v110
  v_dot2c_f32_bf16 v142, v214, v112
  v_dot2c_f32_bf16 v143, v214, v114
  v_dot2c_f32_bf16 v144, v214, v116
  v_dot2c_f32_bf16 v145, v214, v118
  v_dot2c_f32_bf16 v140, v214, v109
  v_dot2c_f32_bf16 v141, v214, v111
  v_dot2c_f32_bf16 v142, v214, v113
  v_dot2c_f32_bf16 v143, v214, v115
  v_dot2c_f32_bf16 v144, v214, v117
  v_dot2c_f32_bf16 v145, v214, v119
  v_dot2c_f32_bf16 v140, v214, v120
  v_dot2c_f32_bf16 v141, v214, v122
  v_dot2c_f32_bf16 v142, v214, v124
  v_dot2c_f32_bf16 v143, v214, v126
  v_dot2c_f32_bf16 v144, v214, v128
  v_dot2c_f32_bf16 v145, v214, v130
  v_dot2c_f32_bf16 v140, v214, v121
  v_dot2c_f32_bf16 v141, v214, v123
  v_dot2c_f32_bf16 v142, v214, v125
  v_dot2c_f32_bf16 v143, v214, v127
  v_dot2c_f32_bf16 v144, v214, v129
  v_dot2c_f32_bf16 v145, v214, v131
  s_add_u32 s32, s65, 2
  v_mov_b32 v228, s32
  s_lshl_b32 s41, s49, 2
  s_add_u32 s41, s41, s63
  s_lshl_b32 s40, s49, 13
  s_add_u32 s40, s40, s61
  s_add_u32 s40, s40, 0x200000
  v_lshlrev_b32 v222, 7, v0
  s_cmp_eq_u32 s51, 0
  s_cselect_b64 exec, 0xffff, -1
  s_cselect_b32 s3, s54, 0
  s_cmp_lg_u32 s3, 0
  s_barrier
  s_cbranch_scc0 Lother_11
  buffer_store_dword v228, v224, s[28:31], s41 offen offset:1024
  s_branch Ljoin_12
Lother_11:
  s_cmp_lg_u32 s51, 0
  s_cbranch_scc1 Lskip_13
  buffer_store_dword v228, v224, s[28:31], s41 offen offset:1024 sc1
Ljoin_12:
  s_mov_b64 exec, -1
  buffer_load_dword v221, v222, s[28:31], s40 offen sc1
Lskip_13:
  s_add_u32 s101, s47, 2
  s_sub_u32 s3, s101, 7
  s_cselect_b32 s101, s101, s3
  s_add_u32 s101, s101, s49
  s_add_u32 s101, s101, 1
  s_and_b32 s101, s101, 7
  s_mul_i32 s101, s101, 0x2b000
  s_add_u32 m0, s52, 0x12000
s_nop 0
  buffer_load_dwordx4 v243, s[16:19], s101 offen lds
  v_cos_f32 v231, v235
  v_add_f32 v235, v235, v234
  v_cvt_pk_bf16_f32 v46, v232, v231
  v_cos_f32 v232, v235
  v_add_f32 v235, v235, v234
  s_add_u32 m0, s52, 0x13000
  s_add_u32 s53, s101, 0x80
  buffer_load_dwordx4 v243, s[16:19], s53 offen lds
  v_cos_f32 v231, v235
  v_add_f32 v235, v235, v233
  v_cvt_pk_bf16_f32 v47, v232, v231
  v_mul_f32 v235, v229, v234
  s_add_u32 m0, s52, 0x14000
  s_add_u32 s53, s101, 0x100
  buffer_load_dwordx4 v242, s[16:19], s53 offen lds
  v_sin_f32 v232, v235
  v_add_f32 v235, v235, v234
  v_sin_f32 v231, v235
  v_add_f32 v235, v235, v234
  v_cvt_pk_bf16_f32 v52, v232, v231
  s_add_u32 s101, s47, 2
  s_sub_u32 s3, s101, 7
  s_cselect_b32 s101, s101, s3
  s_add_u32 s101, s101, s49
  s_add_u32 s101, s101, 1
  s_and_b32 s101, s101, 7
  s_mul_i32 s101, s101, 0x2b000
  s_add_u32 s101, s101, 0x15800
  s_add_u32 m0, s52, 0x15000
s_nop 0
  buffer_load_dwordx4 v243, s[16:19], s101 offen lds
  v_sin_f32 v232, v235
  v_add_f32 v235, v235, v234
  v_sin_f32 v231, v235
  v_add_f32 v235, v235, v233
  v_cvt_pk_bf16_f32 v53, v232, v231
  s_add_u32 m0, s52, 0x16000
  s_add_u32 s53, s101, 0x80
  buffer_load_dwordx4 v243, s[16:19], s53 offen lds
  v_sin_f32 v232, v235
  v_add_f32 v235, v235, v234
  v_sin_f32 v231, v235
  v_add_f32 v235, v235, v234
  v_cvt_pk_bf16_f32 v54, v232, v231
  s_add_u32 m0, s52, 0x17000
  s_add_u32 s53, s101, 0x100
  buffer_load_dwordx4 v242, s[16:19], s53 offen lds
  v_sin_f32 v232, v235
  v_add_f32 v235, v235, v234
  v_sin_f32 v231, v235
  v_add_f32 v235, v235, v233
  v_cvt_pk_bf16_f32 v55, v232, v231
  s_waitcnt vmcnt(6)
  ds_read_b64_tr_b16 v[108:109], v213 offset:24576
  ds_read_b64_tr_b16 v[110:111], v212 offset:24576
  ds_read_b64_tr_b16 v[112:113], v213 offset:28672
  ds_read_b64_tr_b16 v[114:115], v212 offset:28672
  ds_read_b64_tr_b16 v[116:117], v213 offset:32768
  ds_read_b64_tr_b16 v[118:119], v212 offset:32768
  ds_read_b64_tr_b16 v[120:121], v213 offset:36864
  ds_read_b64_tr_b16 v[122:123], v212 offset:36864
  ds_read_b64_tr_b16 v[124:125], v213 offset:40960
  ds_read_b64_tr_b16 v[126:127], v212 offset:40960
  ds_read_b64_tr_b16 v[128:129], v213 offset:45056
  ds_read_b64_tr_b16 v[130:131], v212 offset:45056
  s_waitcnt lgkmcnt(0)
  v_dot2c_f32_bf16 v140, v214, v108
  v_dot2c_f32_bf16 v141, v214, v110
  v_dot2c_f32_bf16 v142, v214, v112
  v_dot2c_f32_bf16 v143, v214, v114
  v_dot2c_f32_bf16 v144, v214, v116
  v_dot2c_f32_bf16 v145, v214, v118
  v_dot2c_f32_bf16 v140, v214, v109
  v_dot2c_f32_bf16 v141, v214, v111
  v_dot2c_f32_bf16 v142, v214, v113
  v_dot2c_f32_bf16 v143, v214, v115
  v_dot2c_f32_bf16 v144, v214, v117
  v_dot2c_f32_bf16 v145, v214, v119
  v_dot2c_f32_bf16 v140, v214, v120
  v_dot2c_f32_bf16 v141, v214, v122
  v_dot2c_f32_bf16 v142, v214, v124
  v_dot2c_f32_bf16 v143, v214, v126
  v_dot2c_f32_bf16 v144, v214, v128
  v_dot2c_f32_bf16 v145, v214, v130
  v_dot2c_f32_bf16 v140, v214, v121
  v_dot2c_f32_bf16 v141, v214, v123
  v_dot2c_f32_bf16 v142, v214, v125
  v_dot2c_f32_bf16 v143, v214, v127
  v_dot2c_f32_bf16 v144, v214, v129
  v_dot2c_f32_bf16 v145, v214, v131
  s_mul_i32 s3, s51, 1536
  s_add_u32 s3, s3, 0x26000
  v_add_u32 v248, s3, v239
  ds_write_b32 v248, v140 offset:0
  ds_write_b32 v248, v141 offset:256
  ds_write_b32 v248, v142 offset:512
  ds_write_b32 v248, v143 offset:768
  ds_write_b32 v248, v144 offset:1024
  ds_write_b32 v248, v145 offset:1280
  s_waitcnt lgkmcnt(0)
  s_lshl_b32 s3, s49, 7
  s_add_u32 s56, s3, 0xe20000
  v_and_b32 v247, 0x7c, v239
  s_add_u32 s66, s65, 1
  s_barrier
  s_cmp_lg_u32 s51, 3
  s_cbranch_scc1 Lw_14
  s_lshl_b32 s3, s49, 5
  s_add_u32 s3, s3, s48
  s_lshl_b32 s3, s3, 2
  s_add_u32 s3, s3, 0xe20000
  s_add_u32 s44, s28, s3
  s_addc_u32 s45, s29, 0
  s_add_u32 s58, s65, 1
  s_atomic_swap s58, s[44:45], 0x0
Lw_14:
  s_add_u32 s101, s47, 0
  s_sub_u32 s3, s101, 7
  s_cselect_b32 s101, s101, s3
  s_add_u32 s101, s101, s49
  s_add_u32 s101, s101, 1
  s_and_b32 s101, s101, 7
  s_mul_i32 s101, s101, 0x2000
  s_add_u32 s101, s101, s61
  s_add_u32 s101, s101, s1
  s_add_u32 m0, s52, 0x20000
  s_add_u32 s53, s101, 0x200000
  buffer_load_dwordx4 v252, s[28:31], s53 offen sc1 lds
  s_xor_b32 s101, s101, 0x1000
  s_add_u32 m0, s52, 0x21000
  s_add_u32 s53, s101, 0x200000
  buffer_load_dwordx4 v252, s[28:31], s53 offen sc1 lds
  s_add_u32 s101, s47, 1
  s_sub_u32 s3, s101, 7
  s_cselect_b32 s101, s101, s3
  s_add_u32 s101, s101, s49
  s_add_u32 s101, s101, 1
  s_and_b32 s101, s101, 7
  s_mul_i32 s101, s101, 0x2000
  s_add_u32 s101, s101, s61
  s_add_u32 s101, s101, s1
  s_add_u32 m0, s52, 0x22000
  s_add_u32 s53, s101, 0x200000
  buffer_load_dwordx4 v252, s[28:31], s53 offen sc1 lds
  s_xor_b32 s101, s101, 0x1000
  s_add_u32 m0, s52, 0x23000
  s_add_u32 s53, s101, 0x200000
  buffer_load_dwordx4 v252, s[28:31], s53 offen sc1 lds
  s_add_u32 s101, s47, 2
  s_sub_u32 s3, s101, 7
  s_cselect_b32 s101, s101, s3
  s_add_u32 s101, s101, s49
  s_add_u32 s101, s101, 1
  s_and_b32 s101, s101, 7
  s_mul_i32 s101, s101, 0x2000
  s_add_u32 s101, s101, s61
  s_add_u32 s101, s101, s1
  s_add_u32 m0, s52, 0x24000
  s_add_u32 s53, s101, 0x200000
  buffer_load_dwordx4 v252, s[28:31], s53 offen sc1 lds
  s_xor_b32 s101, s101, 0x1000
  s_add_u32 m0, s52, 0x25000
  s_add_u32 s53, s101, 0x200000
  buffer_load_dwordx4 v252, s[28:31], s53 offen sc1 lds
  s_add_u32 s101, s47, 3
  s_sub_u32 s3, s101, 7
  s_cselect_b32 s101, s101, s3
  s_add_u32 s101, s101, s49
  s_add_u32 s101, s101, 1
  s_and_b32 s101, s101, 7
  s_mul_i32 s101, s101, 0x2000
  s_add_u32 s101, s101, s61
  s_add_u32 s101, s101, s1
  s_add_u32 m0, s52, 0x1e000
  s_add_u32 s53, s101, 0x200000
  buffer_load_dwordx4 v252, s[28:31], s53 offen sc1 lds
  s_xor_b32 s101, s101, 0x1000
  s_add_u32 m0, s52, 0x1f000
  s_add_u32 s53, s101, 0x200000
  buffer_load_dwordx4 v252, s[28:31], s53 offen sc1 lds
  s_cmp_ge_u32 s51, 3
  s_cbranch_scc1 Lcs_15
  s_lshl_b32 s3, s51, 9
  s_add_u32 s3, s3, 0x26000
  v_and_b32 v248, 0x7c, v239
  v_lshrrev_b32 v249, 5, v0
  v_lshl_add_u32 v248, v249, 8, v248
  v_add_u32 v248, s3, v248
  ds_read_b32 v108, v248 offset:0
  ds_read_b32 v109, v248 offset:128
  ds_read_b32 v110, v248 offset:1536
  ds_read_b32 v111, v248 offset:1664
  ds_read_b32 v112, v248 offset:3072
  ds_read_b32 v113, v248 offset:3200
  ds_read_b32 v114, v248 offset:4608
  ds_read_b32 v115, v248 offset:4736
  s_lshr_b32 s3, s48, 4
  s_lshl_b32 s3, s3, 2
  s_add_u32 s3, s3, s100
  s_lshl_b32 s3, s3, 3
  s_add_u32 s3, s3, s49
  s_lshl_b32 s3, s3, 2
  s_and_b32 s55, s2, 3
  s_add_u32 s3, s3, s55
  s_mul_i32 s3, s3, 3
  s_add_u32 s3, s3, s51
  s_lshl_b32 s3, s3, 9
  s_add_u32 s3, s3, 0xe30000
  v_lshlrev_b32 v248, 3, v0
  s_waitcnt lgkmcnt(0)
  v_add_f32 v108, v108, v112
  v_add_f32 v109, v109, v113
  v_add_f32 v110, v110, v114
  v_add_f32 v111, v111, v115
  v_add_f32 v108, v108, v110
  v_add_f32 v109, v109, v111
  v_add_f32 v108, v108, v109
  v_cvt_pk_bf16_f32 v109, v108, v108
  v_lshlrev_b32 v109, 16, v109
  v_sub_f32 v109, v108, v109
  v_cvt_pk_bf16_f32 v108, v108, v109
  v_mov_b32 v109, s65
  buffer_store_dwordx2 v[108:109], v248, s[28:31], s3 offen sc1
Lcs_15:
  s_lshl_b32 s3, s2, 2
  s_add_u32 s3, s3, s51
  s_mul_i32 s3, s3, 1408
  s_min_u32 s3, s3, 0x157a80
  s_add_u32 s44, s20, s3
  s_addc_u32 s45, s21, 0
  s_load_dword s0, s[44:45], 0x280
  s_load_dword s0, s[44:45], 0x2c0
  s_load_dword s0, s[44:45], 0x300
  s_load_dword s0, s[44:45], 0x340
  s_load_dword s0, s[44:45], 0x380
  s_load_dword s0, s[44:45], 0x3c0
  s_load_dword s0, s[44:45], 0x400
  s_load_dword s0, s[44:45], 0x440
  s_load_dword s0, s[44:45], 0x480
  s_load_dword s0, s[44:45], 0x4c0
  s_load_dword s0, s[44:45], 0x500
  s_load_dword s0, s[44:45], 0x540
  s_cmp_lg_u32 s51, 1
  s_cbranch_scc1 Lw_16
  s_lshr_b32 s3, s2, 3
  s_mul_i32 s3, s3, 43
  v_min_u32 v225, 42, v0
  v_add_u32 v225, s3, v225
  v_lshlrev_b32 v225, 10, v225
  buffer_load_dword v225, v225, s[20:23], 0 offen offset:384
Lw_16:
  s_waitcnt vmcnt(6)
  s_barrier
  s_add_u32 s101, s47, 4
  s_sub_u32 s3, s101, 7
  s_cselect_b32 s101, s101, s3
  s_add_u32 s101, s101, s49
  s_add_u32 s101, s101, 1
  s_and_b32 s101, s101, 7
  s_mul_i32 s101, s101, 0x2b000
  s_add_u32 m0, s52, 0x0
s_nop 0
  buffer_load_dwordx4 v243, s[16:19], s101 offen lds
  s_add_u32 m0, s52, 0x1000
  s_add_u32 s53, s101, 0x80
  buffer_load_dwordx4 v243, s[16:19], s53 offen lds
  s_add_u32 m0, s52, 0x2000
  s_add_u32 s53, s101, 0x100
  buffer_load_dwordx4 v242, s[16:19], s53 offen lds
  s_add_u32 s101, s47, 4
  s_sub_u32 s3, s101, 7
  s_cselect_b32 s101, s101, s3
  s_add_u32 s101, s101, s49
  s_add_u32 s101, s101, 1
  s_and_b32 s101, s101, 7
  s_mul_i32 s101, s101, 0x2b000
  s_add_u32 s101, s101, 0x15800
  s_add_u32 m0, s52, 0x3000
s_nop 0
  buffer_load_dwordx4 v243, s[16:19], s101 offen lds
  s_add_u32 m0, s52, 0x4000
  s_add_u32 s53, s101, 0x80
  buffer_load_dwordx4 v243, s[16:19], s53 offen lds
  s_add_u32 m0, s52, 0x5000
  s_add_u32 s53, s101, 0x100
  buffer_load_dwordx4 v242, s[16:19], s53 offen lds
  v_add_u32 v230, 16, v237
  v_cvt_f32_u32 v230, v230
  v_mul_f32 v234, 0x3d000000, v230
  v_mul_f32 v233, 0x3ed00000, v230
  v_mul_f32 v235, v229, v234
  v_cos_f32 v232, v235
  v_add_f32 v235, v235, v234
  v_cos_f32 v231, v235
  v_add_f32 v235, v235, v234
  v_cvt_pk_bf16_f32 v48, v232, v231
  v_cos_f32 v232, v235
  v_add_f32 v235, v235, v234
  v_cos_f32 v231, v235
  v_add_f32 v235, v235, v233
  v_cvt_pk_bf16_f32 v49, v232, v231
  v_cos_f32 v232, v235
  v_add_f32 v235, v235, v234
  v_cos_f32 v231, v235
  v_add_f32 v235, v235, v234
  v_cvt_pk_bf16_f32 v50, v232, v231
  s_waitcnt vmcnt(10)
  s_barrier
  s_add_u32 s101, s47, 5
  s_sub_u32 s3, s101, 7
  s_cselect_b32 s101, s101, s3
  s_add_u32 s101, s101, s49
  s_add_u32 s101, s101, 1
  s_and_b32 s101, s101, 7
  s_mul_i32 s101, s101, 0x2b000
  s_add_u32 m0, s52, 0x6000
s_nop 0
  buffer_load_dwordx4 v243, s[16:19], s101 offen lds
  s_add_u32 m0, s52, 0x7000
  s_add_u32 s53, s101, 0x80
  buffer_load_dwordx4 v243, s[16:19], s53 offen lds
  s_add_u32 m0, s52, 0x8000
  s_add_u32 s53, s101, 0x100
  buffer_load_dwordx4 v242, s[16:19], s53 offen lds
  s_add_u32 s101, s47, 5
  s_sub_u32 s3, s101, 7
  s_cselect_b32 s101, s101, s3
  s_add_u32 s101, s101, s49
  s_add_u32 s101, s101, 1
  s_and_b32 s101, s101, 7
  s_mul_i32 s101, s101, 0x2b000
  s_add_u32 s101, s101, 0x15800
  s_add_u32 m0, s52, 0x9000
s_nop 0
  buffer_load_dwordx4 v243, s[16:19], s101 offen lds
  s_add_u32 m0, s52, 0xa000
  s_add_u32 s53, s101, 0x80
  buffer_load_dwordx4 v243, s[16:19], s53 offen lds
  s_add_u32 m0, s52, 0xb000
  s_add_u32 s53, s101, 0x100
  buffer_load_dwordx4 v242, s[16:19], s53 offen lds
  v_cos_f32 v232, v235
  v_add_f32 v235, v235, v234
  v_cos_f32 v231, v235
  v_add_f32 v235, v235, v233
  v_cvt_pk_bf16_f32 v51, v232, v231
  v_mul_f32 v235, v229, v234
  v_sin_f32 v232, v235
  v_add_f32 v235, v235, v234
  v_sin_f32 v231, v235
  v_add_f32 v235, v235, v234
  v_cvt_pk_bf16_f32 v56, v232, v231
  v_sin_f32 v232, v235
  v_add_f32 v235, v235, v234
  v_sin_f32 v231, v235
  v_add_f32 v235, v235, v233
  v_cvt_pk_bf16_f32 v57, v232, v231
  v_sin_f32 v232, v235
  v_add_f32 v235, v235, v234
  s_waitcnt vmcnt(14)
  s_barrier
  s_add_u32 s101, s47, 4
  s_sub_u32 s3, s101, 7
  s_cselect_b32 s101, s101, s3
  s_add_u32 s101, s101, s49
  s_add_u32 s101, s101, 1
  s_and_b32 s101, s101, 7
  s_mul_i32 s101, s101, 0x2000
  s_add_u32 s101, s101, s61
  s_add_u32 s101, s101, s1
  s_add_u32 m0, s52, 0x20000
  s_add_u32 s53, s101, 0x200000
  buffer_load_dwordx4 v252, s[28:31], s53 offen sc1 lds
  s_xor_b32 s101, s101, 0x1000
  s_add_u32 m0, s52, 0x21000
  s_add_u32 s53, s101, 0x200000
  buffer_load_dwordx4 v252, s[28:31], s53 offen sc1 lds
  s_add_u32 s101, s47, 6
  s_sub_u32 s3, s101, 7
  s_cselect_b32 s101, s101, s3
  s_add_u32 s101, s101, s49
  s_add_u32 s101, s101, 1
  s_and_b32 s101, s101, 7
  s_mul_i32 s101, s101, 0x2b000
  s_add_u32 m0, s52, 0xc000
s_nop 0
  buffer_load_dwordx4 v243, s[16:19], s101 offen lds
  s_add_u32 m0, s52, 0xd000
  s_add_u32 s53, s101, 0x80
  buffer_load_dwordx4 v243, s[16:19], s53 offen lds
  s_add_u32 m0, s52, 0xe000
  s_add_u32 s53, s101, 0x100
  buffer_load_dwordx4 v242, s[16:19], s53 offen lds
  buffer_load_dword v246, v247, s[28:31], s56 offen sc1
  v_sin_f32 v231, v235
  v_add_f32 v235, v235, v234
  v_cvt_pk_bf16_f32 v58, v232, v231
  v_sin_f32 v232, v235
  v_add_f32 v235, v235, v234
  v_sin_f32 v231, v235
  v_add_f32 v235, v235, v233
  v_cvt_pk_bf16_f32 v59, v232, v231
  s_waitcnt vmcnt(18)
  s_barrier
  s_lshl_b32 s55, s48, 13
  s_add_u32 m0, s52, 0x12000
  s_add_u32 s53, s55, 0x980000
  buffer_load_dwordx4 v252, s[28:31], s53 offen sc1 lds
  s_add_u32 m0, s52, 0x13000
  s_add_u32 s53, s55, 0x981000
  buffer_load_dwordx4 v252, s[28:31], s53 offen sc1 lds
  s_add_u32 s101, s47, 5
  s_sub_u32 s3, s101, 7
  s_cselect_b32 s101, s101, s3
  s_add_u32 s101, s101, s49
  s_add_u32 s101, s101, 1
  s_and_b32 s101, s101, 7
  s_mul_i32 s101, s101, 0x2000
  s_add_u32 s101, s101, s61
  s_add_u32 s101, s101, s1
  s_add_u32 m0, s52, 0x22000
  s_add_u32 s53, s101, 0x200000
  buffer_load_dwordx4 v252, s[28:31], s53 offen sc1 lds
  s_xor_b32 s101, s101, 0x1000
  s_add_u32 m0, s52, 0x23000
  s_add_u32 s53, s101, 0x200000
  buffer_load_dwordx4 v252, s[28:31], s53 offen sc1 lds
  s_add_u32 s101, s47, 6
  s_sub_u32 s3, s101, 7
  s_cselect_b32 s101, s101, s3
  s_add_u32 s101, s101, s49
  s_add_u32 s101, s101, 1
  s_and_b32 s101, s101, 7
  s_mul_i32 s101, s101, 0x2b000
  s_add_u32 s101, s101, 0x15800
  s_add_u32 m0, s52, 0xf000
s_nop 0
  buffer_load_dwordx4 v243, s[16:19], s101 offen lds
  s_add_u32 m0, s52, 0x10000
  s_add_u32 s53, s101, 0x80
  buffer_load_dwordx4 v243, s[16:19], s53 offen lds
  s_add_u32 m0, s52, 0x11000
  s_add_u32 s53, s101, 0x100
  buffer_load_dwordx4 v242, s[16:19], s53 offen lds
  s_waitcnt vmcnt(11)
  s_barrier
  s_add_u32 s101, s47, 6
  s_sub_u32 s3, s101, 7
  s_cselect_b32 s101, s101, s3
  s_add_u32 s101, s101, s49
  s_add_u32 s101, s101, 1
  s_and_b32 s101, s101, 7
  s_mul_i32 s101, s101, 0x2000
  s_add_u32 s101, s101, s61
  s_add_u32 s101, s101, s1
  s_add_u32 m0, s52, 0x24000
  s_add_u32 s53, s101, 0x200000
  buffer_load_dwordx4 v252, s[28:31], s53 offen sc1 lds
  s_xor_b32 s101, s101, 0x1000
  s_add_u32 m0, s52, 0x25000
  s_add_u32 s53, s101, 0x200000
  buffer_load_dwordx4 v252, s[28:31], s53 offen sc1 lds
  s_lshr_b32 s3, s48, 4
  s_lshl_b32 s3, s3, 2
  s_add_u32 s3, s3, s100
  s_lshl_b32 s3, s3, 3
  s_add_u32 s3, s3, s49
  s_mul_i32 s55, s3, 0x1800
  s_add_u32 m0, s52, 0x26000
  s_add_u32 s53, s55, 0xe30000
  buffer_load_dwordx4 v252, s[28:31], s53 offen sc1 lds
  s_cmp_ge_u32 s51, 2
  s_cbranch_scc1 Lcs2_17
  s_add_u32 m0, s52, 0x27000
  s_add_u32 s53, s55, 0xe31000
  buffer_load_dwordx4 v252, s[28:31], s53 offen sc1 lds
Lcs2_17:
  s_waitcnt vmcnt(10)
  v_cmp_eq_u32 vcc, s66, v246
s_nop 0
  s_cmp_eq_u64 vcc, exec
  s_cbranch_scc1 Lok_18
  s_mov_b32 s59, 0
Lpoll_19:
  buffer_load_dword v246, v247, s[28:31], s56 offen sc1
  s_waitcnt vmcnt(0)
  v_cmp_eq_u32 vcc, s66, v246
  s_add_u32 s59, s59, 1
  s_cmp_eq_u64 vcc, exec
  s_cbranch_scc1 Lpollok_20
  s_cmp_lt_u32 s59, 0x40000
  s_cbranch_scc1 Lpoll_19
Lpollok_20:
Lok_18:
  s_mul_i32 s55, s64, 8448
  s_add_u32 m0, s52, 0x18000
  s_add_u32 s53, s55, 0x9bdf00
  buffer_load_dwordx4 v252, s[28:31], s53 offen sc1 lds
  s_add_u32 m0, s52, 0x19000
  s_add_u32 s53, s55, 0x9bef80
  buffer_load_dwordx4 v252, s[28:31], s53 offen sc1 lds
  s_waitcnt vmcnt(8)
  s_barrier
  s_add_u32 s101, s35, 0
  s_sub_u32 s3, s101, 21
  s_cselect_b32 s101, s101, s3
  s_mul_i32 s101, s101, 0x10000
  s_add_u32 m0, s52, 0x14000
s_nop 0
  buffer_load_dwordx4 v244, s[20:23], s101 offen lds
  s_add_u32 m0, s52, 0x15000
  s_add_u32 s53, s101, 0x8000
  buffer_load_dwordx4 v244, s[20:23], s53 offen lds
  s_add_u32 s101, s35, 1
  s_sub_u32 s3, s101, 21
  s_cselect_b32 s101, s101, s3
  s_mul_i32 s101, s101, 0x10000
  s_add_u32 m0, s52, 0x16000
s_nop 0
  buffer_load_dwordx4 v244, s[20:23], s101 offen lds
  s_add_u32 m0, s52, 0x17000
  s_add_u32 s53, s101, 0x8000
  buffer_load_dwordx4 v244, s[20:23], s53 offen lds
  s_add_u32 s101, s35, 2
  s_sub_u32 s3, s101, 21
  s_cselect_b32 s101, s101, s3
  s_mul_i32 s101, s101, 0x10000
  s_add_u32 m0, s52, 0x1a000
s_nop 0
  buffer_load_dwordx4 v244, s[20:23], s101 offen lds
  s_add_u32 m0, s52, 0x1b000
  s_add_u32 s53, s101, 0x8000
  buffer_load_dwordx4 v244, s[20:23], s53 offen lds
  s_waitcnt vmcnt(9)
  s_barrier
  s_add_u32 s101, s35, 3
  s_sub_u32 s3, s101, 21
  s_cselect_b32 s101, s101, s3
  s_mul_i32 s101, s101, 0x10000
  s_add_u32 m0, s52, 0x1c000
s_nop 0
  buffer_load_dwordx4 v244, s[20:23], s101 offen lds
  s_add_u32 m0, s52, 0x1d000
  s_add_u32 s53, s101, 0x8000
  buffer_load_dwordx4 v244, s[20:23], s53 offen lds
  s_add_u32 s101, s35, 4
  s_sub_u32 s3, s101, 21
  s_cselect_b32 s101, s101, s3
  s_mul_i32 s101, s101, 0x10000
  s_add_u32 m0, s52, 0x1e000
s_nop 0
  buffer_load_dwordx4 v244, s[20:23], s101 offen lds
  s_add_u32 m0, s52, 0x1f000
  s_add_u32 s53, s101, 0x8000
  buffer_load_dwordx4 v244, s[20:23], s53 offen lds
  s_add_u32 s101, s35, 5
  s_sub_u32 s3, s101, 21
  s_cselect_b32 s101, s101, s3
  s_mul_i32 s101, s101, 0x10000
  s_add_u32 m0, s52, 0x0
s_nop 0
  buffer_load_dwordx4 v244, s[20:23], s101 offen lds
  s_add_u32 m0, s52, 0x1000
  s_add_u32 s53, s101, 0x8000
  buffer_load_dwordx4 v244, s[20:23], s53 offen lds
  s_waitcnt vmcnt(12)
  s_barrier
  ds_read_b64_tr_b16 v[108:109], v220 offset:0
  ds_read_b64_tr_b16 v[110:111], v220 offset:256
  ds_read_b64_tr_b16 v[124:125], v220 offset:4096
  ds_read_b64_tr_b16 v[126:127], v220 offset:4352
  ds_read_b64_tr_b16 v[112:113], v220 offset:2048
  ds_read_b64_tr_b16 v[114:115], v220 offset:2304
  ds_read_b64_tr_b16 v[128:129], v220 offset:6144
  ds_read_b64_tr_b16 v[130:131], v220 offset:6400
  ds_read_b64_tr_b16 v[116:117], v220 offset:32
  ds_read_b64_tr_b16 v[118:119], v220 offset:288
  ds_read_b64_tr_b16 v[132:133], v220 offset:4128
  ds_read_b64_tr_b16 v[134:135], v220 offset:4384
  ds_read_b64_tr_b16 v[120:121], v220 offset:2080
  ds_read_b64_tr_b16 v[122:123], v220 offset:2336
  ds_read_b64_tr_b16 v[136:137], v220 offset:6176
  ds_read_b64_tr_b16 v[138:139], v220 offset:6432
  s_cmp_lg_u32 s51, 2
  s_cbranch_scc1 Lw_21
  v_and_b32 v223, 7, v0
  v_lshlrev_b32 v223, 7, v223
  buffer_load_dword v223, v223, s[28:31], s63 offen offset:2048 sc1
Lw_21:
  s_add_u32 s101, s35, 6
  s_sub_u32 s3, s101, 21
  s_cselect_b32 s101, s101, s3
  s_mul_i32 s101, s101, 0x10000
  s_add_u32 m0, s52, 0x2000
s_nop 0
  buffer_load_dwordx4 v244, s[20:23], s101 offen lds
  s_add_u32 m0, s52, 0x3000
  s_add_u32 s53, s101, 0x8000
  buffer_load_dwordx4 v244, s[20:23], s53 offen lds
  s_add_u32 s101, s35, 7
  s_sub_u32 s3, s101, 21
  s_cselect_b32 s101, s101, s3
  s_mul_i32 s101, s101, 0x10000
  s_add_u32 m0, s52, 0x4000
s_nop 0
  buffer_load_dwordx4 v244, s[20:23], s101 offen lds
  s_add_u32 m0, s52, 0x5000
  s_add_u32 s53, s101, 0x8000
  buffer_load_dwordx4 v244, s[20:23], s53 offen lds
  s_add_u32 s101, s35, 8
  s_sub_u32 s3, s101, 21
  s_cselect_b32 s101, s101, s3
  s_mul_i32 s101, s101, 0x10000
  s_add_u32 m0, s52, 0x20000
s_nop 0
  buffer_load_dwordx4 v244, s[20:23], s101 offen lds
  s_add_u32 m0, s52, 0x21000
  s_add_u32 s53, s101, 0x8000
  buffer_load_dwordx4 v244, s[20:23], s53 offen lds
  s_add_u32 s101, s35, 9
  s_sub_u32 s3, s101, 21
  s_cselect_b32 s101, s101, s3
  s_mul_i32 s101, s101, 0x10000
  s_add_u32 m0, s52, 0x6000
s_nop 0
  buffer_load_dwordx4 v244, s[20:23], s101 offen lds
  s_add_u32 m0, s52, 0x7000
  s_add_u32 s53, s101, 0x8000
  buffer_load_dwordx4 v244, s[20:23], s53 offen lds
  s_add_u32 s101, s35, 10
  s_sub_u32 s3, s101, 21
  s_cselect_b32 s101, s101, s3
  s_mul_i32 s101, s101, 0x10000
  s_add_u32 m0, s52, 0x8000
s_nop 0
  buffer_load_dwordx4 v244, s[20:23], s101 offen lds
  s_add_u32 m0, s52, 0x9000
  s_add_u32 s53, s101, 0x8000
  buffer_load_dwordx4 v244, s[20:23], s53 offen lds
  s_add_u32 s101, s35, 11
  s_sub_u32 s3, s101, 21
  s_cselect_b32 s101, s101, s3
  s_mul_i32 s101, s101, 0x10000
  s_add_u32 m0, s52, 0xa000
s_nop 0
  buffer_load_dwordx4 v244, s[20:23], s101 offen lds
  s_add_u32 m0, s52, 0xb000
  s_add_u32 s53, s101, 0x8000
  buffer_load_dwordx4 v244, s[20:23], s53 offen lds
  s_add_u32 s101, s35, 12
  s_sub_u32 s3, s101, 21
  s_cselect_b32 s101, s101, s3
  s_mul_i32 s101, s101, 0x10000
  s_add_u32 m0, s52, 0x22000
s_nop 0
  buffer_load_dwordx4 v244, s[20:23], s101 offen lds
  s_add_u32 m0, s52, 0x23000
  s_add_u32 s53, s101, 0x8000
  buffer_load_dwordx4 v244, s[20:23], s53 offen lds
  s_add_u32 s101, s35, 13
  s_sub_u32 s3, s101, 21
  s_cselect_b32 s101, s101, s3
  s_mul_i32 s101, s101, 0x10000
  s_add_u32 m0, s52, 0x12000
s_nop 0
  buffer_load_dwordx4 v244, s[20:23], s101 offen lds
  s_add_u32 m0, s52, 0x13000
  s_add_u32 s53, s101, 0x8000
  buffer_load_dwordx4 v244, s[20:23], s53 offen lds
  s_waitcnt vmcnt(6)
  s_barrier
  s_mov_b32 s38, 0x4a524924
  s_mov_b32 s39, 0x529
  s_setprio 2
  s_waitcnt lgkmcnt(12)
  v_mfma_f32_16x16x32_bf16 v[60:63], v[108:111], v[4:7], 0
  v_mfma_f32_16x16x32_bf16 v[68:71], v[124:127], v[4:7], 0
  v_mfma_f32_16x16x32_bf16 v[60:63], v[124:127], v[12:15], v[60:63]
  v_mfma_f32_16x16x32_bf16 v[68:71], v[108:111], v[20:23], v[68:71]
  s_waitcnt lgkmcnt(8)
  v_mfma_f32_16x16x32_bf16 v[60:63], v[112:115], v[8:11], v[60:63]
  v_mfma_f32_16x16x32_bf16 v[68:71], v[128:131], v[8:11], v[68:71]
  v_mfma_f32_16x16x32_bf16 v[60:63], v[128:131], v[16:19], v[60:63]
  v_mfma_f32_16x16x32_bf16 v[68:71], v[112:115], v[24:27], v[68:71]
  s_waitcnt lgkmcnt(4)
  v_mfma_f32_16x16x32_bf16 v[64:67], v[116:119], v[4:7], 0
  v_mfma_f32_16x16x32_bf16 v[72:75], v[132:135], v[4:7], 0
  v_mfma_f32_16x16x32_bf16 v[64:67], v[132:135], v[12:15], v[64:67]
  v_mfma_f32_16x16x32_bf16 v[72:75], v[116:119], v[20:23], v[72:75]
  s_waitcnt lgkmcnt(0)
  v_mfma_f32_16x16x32_bf16 v[64:67], v[120:123], v[8:11], v[64:67]
  v_mfma_f32_16x16x32_bf16 v[72:75], v[136:139], v[8:11], v[72:75]
  v_mfma_f32_16x16x32_bf16 v[64:67], v[136:139], v[16:19], v[64:67]
  v_mfma_f32_16x16x32_bf16 v[72:75], v[120:123], v[24:27], v[72:75]
  v_pk_mul_f32 v[108:109], v[60:61], v[28:29]
  v_pk_mul_f32 v[116:117], v[68:69], v[28:29]
  v_pk_mul_f32 v[110:111], v[62:63], v[30:31]
  v_pk_mul_f32 v[118:119], v[70:71], v[30:31]
s_nop 2
  v_pk_mul_f32 v[112:113], v[64:65], v[32:33]
  v_pk_mul_f32 v[120:121], v[72:73], v[32:33]
  v_pk_mul_f32 v[114:115], v[66:67], v[34:35]
  v_pk_mul_f32 v[122:123], v[74:75], v[34:35]
  v_pk_fma_f32 v[108:109], v[68:69], v[36:37], v[108:109]
  v_pk_fma_f32 v[116:117], v[60:61], v[36:37], v[116:117] neg_lo:[1,0,0] neg_hi:[1,0,0]
  v_pk_fma_f32 v[110:111], v[70:71], v[38:39], v[110:111]
  v_pk_fma_f32 v[118:119], v[62:63], v[38:39], v[118:119] neg_lo:[1,0,0] neg_hi:[1,0,0]
  v_pk_fma_f32 v[112:113], v[72:73], v[40:41], v[112:113]
  v_pk_fma_f32 v[120:121], v[64:65], v[40:41], v[120:121] neg_lo:[1,0,0] neg_hi:[1,0,0]
  v_pk_fma_f32 v[114:115], v[74:75], v[42:43], v[114:115]
  v_pk_fma_f32 v[122:123], v[66:67], v[42:43], v[122:123] neg_lo:[1,0,0] neg_hi:[1,0,0]
  v_cvt_pk_bf16_f32 v124, v108, v109
  v_cvt_pk_bf16_f32 v125, v110, v111
  v_cvt_pk_bf16_f32 v126, v112, v113
  v_cvt_pk_bf16_f32 v127, v114, v115
  v_cvt_pk_bf16_f32 v128, v116, v117
  v_cvt_pk_bf16_f32 v129, v118, v119
  v_cvt_pk_bf16_f32 v130, v120, v121
  v_cvt_pk_bf16_f32 v131, v122, v123
  v_mfma_f32_16x16x32_bf16 v[76:79], v[124:127], v[44:47], 0
  v_mfma_f32_16x16x32_bf16 v[80:83], v[124:127], v[48:51], 0
  v_mfma_f32_16x16x32_bf16 v[76:79], v[128:131], v[52:55], v[76:79]
  v_mfma_f32_16x16x32_bf16 v[80:83], v[128:131], v[56:59], v[80:83]
s_nop 6
  v_cvt_pk_bf16_f32 v108, v76, v77
  v_cvt_pk_bf16_f32 v109, v78, v79
  v_cvt_pk_bf16_f32 v110, v80, v81
  v_cvt_pk_bf16_f32 v111, v82, v83
  ds_write_b64 v219, v[108:109] offset:0
  ds_write_b64 v219, v[110:111] offset:2048
  s_waitcnt lgkmcnt(0)
  s_barrier
  s_cmp_ge_u32 s51, 2
  s_cbranch_scc1 Lymir_22
  ds_read_b128 v[116:119], v218 offset:0
  ds_read_b128 v[120:123], v218 offset:1024
  s_waitcnt lgkmcnt(0)
  s_branch Lyjoin_23
Lymir_22:
  ds_read_b128 v[124:127], v218 offset:1024
  ds_read_b128 v[132:135], v218 offset:0
  ds_read_b32 v128, v216
  ds_read_b32 v136, v217
  s_mov_b32 s3, 0xffff
  s_waitcnt lgkmcnt(0)
  v_bfi_b32 v116, s3, v128, v127
  v_bfi_b32 v117, s3, v127, v126
  v_bfi_b32 v118, s3, v126, v125
  v_bfi_b32 v119, s3, v125, v124
  v_bfi_b32 v120, s3, v136, v135
  v_bfi_b32 v121, s3, v135, v134
  v_bfi_b32 v122, s3, v134, v133
  v_bfi_b32 v123, s3, v133, v132
  s_cmp_lg_u32 s57, 0
  s_cbranch_scc1 Lyz_24
  v_mov_b32 v116, 0
  v_mov_b32 v117, 0
  v_mov_b32 v118, 0
  v_mov_b32 v119, 0
  v_mov_b32 v120, 0
  v_mov_b32 v121, 0
  v_mov_b32 v122, 0
  v_mov_b32 v123, 0
Lyz_24:
Lyjoin_23:
  s_mul_i32 s3, s57, 4224
  s_lshl_b32 s42, s42, 11
  s_add_u32 s3, s3, s42
  s_add_u32 s3, s3, 0xbe0000
  buffer_store_dwordx4 v[116:119], v238, s[28:31], s3 offen offset:0 sc1
  buffer_store_dwordx4 v[120:123], v238, s[28:31], s3 offen offset:1024 sc1
  s_setprio 0
  s_add_u32 s32, s65, 3
  v_mov_b32 v228, s32
  s_lshl_b32 s41, s49, 2
  s_add_u32 s41, s41, s63
  s_cmp_eq_u32 s51, 0
  s_cselect_b64 exec, 0xffff, -1
  s_cselect_b32 s3, s54, 0
  s_cmp_lg_u32 s3, 0
  s_barrier
  s_cbranch_scc0 Lother_25
  buffer_store_dword v228, v224, s[28:31], s41 offen offset:2048
  s_branch Ljoin_26
Lother_25:
  s_cmp_lg_u32 s51, 0
  s_cbranch_scc1 Lskip_27
  buffer_store_dword v228, v224, s[28:31], s41 offen offset:2048 sc1
Ljoin_26:
  s_mov_b64 exec, -1
Lskip_27:
  s_add_u32 s101, s35, 14
  s_sub_u32 s3, s101, 21
  s_cselect_b32 s101, s101, s3
  s_mul_i32 s101, s101, 0x10000
  s_add_u32 m0, s52, 0x14000
s_nop 0
  buffer_load_dwordx4 v244, s[20:23], s101 offen lds
  s_add_u32 m0, s52, 0x15000
  s_add_u32 s53, s101, 0x8000
  buffer_load_dwordx4 v244, s[20:23], s53 offen lds
  s_add_u32 s101, s35, 15
  s_sub_u32 s3, s101, 21
  s_cselect_b32 s101, s101, s3
  s_mul_i32 s101, s101, 0x10000
  s_add_u32 m0, s52, 0x16000
s_nop 0
  buffer_load_dwordx4 v244, s[20:23], s101 offen lds
  s_add_u32 m0, s52, 0x17000
  s_add_u32 s53, s101, 0x8000
  buffer_load_dwordx4 v244, s[20:23], s53 offen lds
  s_add_u32 s101, s35, 16
  s_sub_u32 s3, s101, 21
  s_cselect_b32 s101, s101, s3
  s_mul_i32 s101, s101, 0x10000
  s_add_u32 m0, s52, 0x1a000
s_nop 0
  buffer_load_dwordx4 v244, s[20:23], s101 offen lds
  s_add_u32 m0, s52, 0x1b000
  s_add_u32 s53, s101, 0x8000
  buffer_load_dwordx4 v244, s[20:23], s53 offen lds
  s_add_u32 s101, s35, 17
  s_sub_u32 s3, s101, 21
  s_cselect_b32 s101, s101, s3
  s_mul_i32 s101, s101, 0x10000
  s_add_u32 m0, s52, 0x1c000
s_nop 0
  buffer_load_dwordx4 v244, s[20:23], s101 offen lds
  s_add_u32 m0, s52, 0x1d000
  s_add_u32 s53, s101, 0x8000
  buffer_load_dwordx4 v244, s[20:23], s53 offen lds
  s_add_u32 s101, s35, 18
  s_sub_u32 s3, s101, 21
  s_cselect_b32 s101, s101, s3
  s_mul_i32 s101, s101, 0x10000
  s_add_u32 m0, s52, 0x1e000
s_nop 0
  buffer_load_dwordx4 v244, s[20:23], s101 offen lds
  s_add_u32 m0, s52, 0x1f000
  s_add_u32 s53, s101, 0x8000
  buffer_load_dwordx4 v244, s[20:23], s53 offen lds
  s_add_u32 s101, s35, 19
  s_sub_u32 s3, s101, 21
  s_cselect_b32 s101, s101, s3
  s_mul_i32 s101, s101, 0x10000
  s_add_u32 m0, s52, 0x0
s_nop 0
  buffer_load_dwordx4 v244, s[20:23], s101 offen lds
  s_add_u32 m0, s52, 0x1000
  s_add_u32 s53, s101, 0x8000
  buffer_load_dwordx4 v244, s[20:23], s53 offen lds
  s_barrier
  s_add_u32 s101, s35, 0
  s_sub_u32 s3, s101, 21
  s_cselect_b32 s101, s101, s3
  s_mul_i32 s101, s101, 0x2000
  s_add_u32 s101, s101, s62
  s_add_u32 m0, s52, 0x10000
s_nop 0
  buffer_load_dwordx4 v252, s[28:31], s101 offen sc1 lds
  s_add_u32 m0, s52, 0x11000
  s_add_u32 s53, s101, 0x1000
  buffer_load_dwordx4 v252, s[28:31], s53 offen sc1 lds
  s_add_u32 s101, s35, 1
  s_sub_u32 s3, s101, 21
  s_cselect_b32 s101, s101, s3
  s_mul_i32 s101, s101, 0x2000
  s_add_u32 s101, s101, s62
  s_add_u32 m0, s52, 0xc000
s_nop 0
  buffer_load_dwordx4 v252, s[28:31], s101 offen sc1 lds
  s_add_u32 m0, s52, 0xd000
  s_add_u32 s53, s101, 0x1000
  buffer_load_dwordx4 v252, s[28:31], s53 offen sc1 lds
  s_add_u32 s101, s35, 2
  s_sub_u32 s3, s101, 21
  s_cselect_b32 s101, s101, s3
  s_mul_i32 s101, s101, 0x2000
  s_add_u32 s101, s101, s62
  s_add_u32 m0, s52, 0xe000
s_nop 0
  buffer_load_dwordx4 v252, s[28:31], s101 offen sc1 lds
  s_add_u32 m0, s52, 0xf000
  s_add_u32 s53, s101, 0x1000
  buffer_load_dwordx4 v252, s[28:31], s53 offen sc1 lds
  s_add_u32 s101, s35, 3
  s_sub_u32 s3, s101, 21
  s_cselect_b32 s101, s101, s3
  s_mul_i32 s101, s101, 0x2000
  s_add_u32 s101, s101, s62
  s_add_u32 m0, s52, 0x24000
s_nop 0
  buffer_load_dwordx4 v252, s[28:31], s101 offen sc1 lds
  s_add_u32 m0, s52, 0x25000
  s_add_u32 s53, s101, 0x1000
  buffer_load_dwordx4 v252, s[28:31], s53 offen sc1 lds
  s_waitcnt vmcnt(6)
  s_barrier
  s_add_u32 s101, s35, 4
  s_sub_u32 s3, s101, 21
  s_cselect_b32 s101, s101, s3
  s_mul_i32 s101, s101, 0x2000
  s_add_u32 s101, s101, s62
  s_add_u32 m0, s52, 0x20000
s_nop 0
  buffer_load_dwordx4 v252, s[28:31], s101 offen sc1 lds
  s_add_u32 m0, s52, 0x21000
  s_add_u32 s53, s101, 0x1000
  buffer_load_dwordx4 v252, s[28:31], s53 offen sc1 lds
  s_add_u32 s101, s35, 5
  s_sub_u32 s3, s101, 21
  s_cselect_b32 s101, s101, s3
  s_mul_i32 s101, s101, 0x2000
  s_add_u32 s101, s101, s62
  s_add_u32 m0, s52, 0x6000
s_nop 0
  buffer_load_dwordx4 v252, s[28:31], s101 offen sc1 lds
  s_add_u32 m0, s52, 0x7000
  s_add_u32 s53, s101, 0x1000
  buffer_load_dwordx4 v252, s[28:31], s53 offen sc1 lds
  s_bitcmp1_b32 s51, 0
  s_cbranch_scc1 Lyflag_28
  s_lshl_b32 s3, s57, 2
  s_add_u32 s3, s3, 0xe21000
  s_add_u32 s44, s28, s3
  s_addc_u32 s45, s29, 0
  s_add_u32 s58, s65, 1
  s_atomic_swap s58, s[44:45], 0x0
Lyflag_28:
  s_waitcnt vmcnt(8)
  s_barrier
  s_add_u32 s101, s35, 6
  s_sub_u32 s3, s101, 21
  s_cselect_b32 s101, s101, s3
  s_mul_i32 s101, s101, 0x2000
  s_add_u32 s101, s101, s62
  s_add_u32 m0, s52, 0x8000
s_nop 0
  buffer_load_dwordx4 v252, s[28:31], s101 offen sc1 lds
  s_add_u32 m0, s52, 0x9000
  s_add_u32 s53, s101, 0x1000
  buffer_load_dwordx4 v252, s[28:31], s53 offen sc1 lds
  s_waitcnt vmcnt(8)
  s_barrier
  s_add_u32 s101, s35, 7
  s_sub_u32 s3, s101, 21
  s_cselect_b32 s101, s101, s3
  s_mul_i32 s101, s101, 0x2000
  s_add_u32 s101, s101, s62
  s_add_u32 m0, s52, 0x10000
s_nop 0
  buffer_load_dwordx4 v252, s[28:31], s101 offen sc1 lds
  s_add_u32 m0, s52, 0x11000
  s_add_u32 s53, s101, 0x1000
  buffer_load_dwordx4 v252, s[28:31], s53 offen sc1 lds
  s_add_u32 s101, s35, 20
  s_sub_u32 s3, s101, 21
  s_cselect_b32 s101, s101, s3
  s_mul_i32 s101, s101, 0x10000
  s_add_u32 m0, s52, 0x2000
s_nop 0
  buffer_load_dwordx4 v244, s[20:23], s101 offen lds
  s_add_u32 m0, s52, 0x3000
  s_add_u32 s53, s101, 0x8000
  buffer_load_dwordx4 v244, s[20:23], s53 offen lds
  s_waitcnt vmcnt(10)
  s_barrier
  s_add_u32 s101, s35, 8
  s_sub_u32 s3, s101, 21
  s_cselect_b32 s101, s101, s3
  s_mul_i32 s101, s101, 0x2000
  s_add_u32 s101, s101, s62
  s_add_u32 m0, s52, 0xc000
s_nop 0
  buffer_load_dwordx4 v252, s[28:31], s101 offen sc1 lds
  s_add_u32 m0, s52, 0xd000
  s_add_u32 s53, s101, 0x1000
  buffer_load_dwordx4 v252, s[28:31], s53 offen sc1 lds
  s_waitcnt vmcnt(10)
  s_barrier
  s_add_u32 s101, s35, 9
  s_sub_u32 s3, s101, 21
  s_cselect_b32 s101, s101, s3
  s_mul_i32 s101, s101, 0x2000
  s_add_u32 s101, s101, s62
  s_add_u32 m0, s52, 0xe000
s_nop 0
  buffer_load_dwordx4 v252, s[28:31], s101 offen sc1 lds
  s_add_u32 m0, s52, 0xf000
  s_add_u32 s53, s101, 0x1000
  buffer_load_dwordx4 v252, s[28:31], s53 offen sc1 lds
  s_add_u32 m0, s52, 0x4000
  s_mov_b32 s53, 0x150000
  buffer_load_dwordx4 v244, s[20:23], s53 offen lds
  s_waitcnt vmcnt(11)
  s_barrier
  s_add_u32 s101, s35, 10
  s_sub_u32 s3, s101, 21
  s_cselect_b32 s101, s101, s3
  s_mul_i32 s101, s101, 0x2000
  s_add_u32 s101, s101, s62
  s_add_u32 m0, s52, 0x24000
s_nop 0
  buffer_load_dwordx4 v252, s[28:31], s101 offen sc1 lds
  s_add_u32 m0, s52, 0x25000
  s_add_u32 s53, s101, 0x1000
  buffer_load_dwordx4 v252, s[28:31], s53 offen sc1 lds
  s_waitcnt vmcnt(11)
  s_barrier
  s_add_u32 s101, s35, 11
  s_sub_u32 s3, s101, 21
  s_cselect_b32 s101, s101, s3
  s_mul_i32 s101, s101, 0x2000
  s_add_u32 s101, s101, s62
  s_add_u32 m0, s52, 0x20000
s_nop 0
  buffer_load_dwordx4 v252, s[28:31], s101 offen sc1 lds
  s_add_u32 m0, s52, 0x21000
  s_add_u32 s53, s101, 0x1000
  buffer_load_dwordx4 v252, s[28:31], s53 offen sc1 lds
  s_waitcnt vmcnt(11)
  s_barrier
  s_add_u32 s101, s35, 12
  s_sub_u32 s3, s101, 21
  s_cselect_b32 s101, s101, s3
  s_mul_i32 s101, s101, 0x2000
  s_add_u32 s101, s101, s62
  s_add_u32 m0, s52, 0x6000
s_nop 0
  buffer_load_dwordx4 v252, s[28:31], s101 offen sc1 lds
  s_add_u32 m0, s52, 0x7000
  s_add_u32 s53, s101, 0x1000
  buffer_load_dwordx4 v252, s[28:31], s53 offen sc1 lds
  s_waitcnt vmcnt(9)
  s_barrier
  s_add_u32 s101, s35, 13
  s_sub_u32 s3, s101, 21
  s_cselect_b32 s101, s101, s3
  s_mul_i32 s101, s101, 0x2000
  s_add_u32 s101, s101, s62
  s_add_u32 m0, s52, 0x8000
s_nop 0
  buffer_load_dwordx4 v252, s[28:31], s101 offen sc1 lds
  s_add_u32 m0, s52, 0x9000
  s_add_u32 s53, s101, 0x1000
  buffer_load_dwordx4 v252, s[28:31], s53 offen sc1 lds
  s_waitcnt vmcnt(9)
  s_barrier
  s_add_u32 s101, s35, 14
  s_sub_u32 s3, s101, 21
  s_cselect_b32 s101, s101, s3
  s_mul_i32 s101, s101, 0x2000
  s_add_u32 s101, s101, s62
  s_add_u32 m0, s52, 0x10000
s_nop 0
  buffer_load_dwordx4 v252, s[28:31], s101 offen sc1 lds
  s_add_u32 m0, s52, 0x11000
  s_add_u32 s53, s101, 0x1000
  buffer_load_dwordx4 v252, s[28:31], s53 offen sc1 lds
  s_waitcnt vmcnt(8)
  s_barrier
  s_add_u32 s101, s35, 15
  s_sub_u32 s3, s101, 21
  s_cselect_b32 s101, s101, s3
  s_mul_i32 s101, s101, 0x2000
  s_add_u32 s101, s101, s62
  s_add_u32 m0, s52, 0xc000
s_nop 0
  buffer_load_dwordx4 v252, s[28:31], s101 offen sc1 lds
  s_add_u32 m0, s52, 0xd000
  s_add_u32 s53, s101, 0x1000
  buffer_load_dwordx4 v252, s[28:31], s53 offen sc1 lds
  s_waitcnt vmcnt(8)
  s_barrier
  s_add_u32 s101, s35, 16
  s_sub_u32 s3, s101, 21
  s_cselect_b32 s101, s101, s3
  s_mul_i32 s101, s101, 0x2000
  s_add_u32 s101, s101, s62
  s_add_u32 m0, s52, 0xe000
s_nop 0
  buffer_load_dwordx4 v252, s[28:31], s101 offen sc1 lds
  s_add_u32 m0, s52, 0xf000
  s_add_u32 s53, s101, 0x1000
  buffer_load_dwordx4 v252, s[28:31], s53 offen sc1 lds
  s_waitcnt vmcnt(8)
  s_barrier
  s_add_u32 s101, s35, 17
  s_sub_u32 s3, s101, 21
  s_cselect_b32 s101, s101, s3
  s_mul_i32 s101, s101, 0x2000
  s_add_u32 s101, s101, s62
  s_add_u32 m0, s52, 0x24000
s_nop 0
  buffer_load_dwordx4 v252, s[28:31], s101 offen sc1 lds
  s_add_u32 m0, s52, 0x25000
  s_add_u32 s53, s101, 0x1000
  buffer_load_dwordx4 v252, s[28:31], s53 offen sc1 lds
  s_lshl_b32 s3, s49, 8
  s_add_u32 s56, s3, 0xe21000
  buffer_load_dword v246, v239, s[28:31], s56 offen sc1
  s_waitcnt vmcnt(9)
  s_barrier
  s_add_u32 s101, s35, 18
  s_sub_u32 s3, s101, 21
  s_cselect_b32 s101, s101, s3
  s_mul_i32 s101, s101, 0x2000
  s_add_u32 s101, s101, s62
  s_add_u32 m0, s52, 0x20000
s_nop 0
  buffer_load_dwordx4 v252, s[28:31], s101 offen sc1 lds
  s_add_u32 m0, s52, 0x21000
  s_add_u32 s53, s101, 0x1000
  buffer_load_dwordx4 v252, s[28:31], s53 offen sc1 lds
  s_add_u32 s101, s35, 19
  s_sub_u32 s3, s101, 21
  s_cselect_b32 s101, s101, s3
  s_mul_i32 s101, s101, 0x2000
  s_add_u32 s101, s101, s62
  s_add_u32 m0, s52, 0xa000
s_nop 0
  buffer_load_dwordx4 v252, s[28:31], s101 offen sc1 lds
  s_add_u32 m0, s52, 0xb000
  s_add_u32 s53, s101, 0x1000
  buffer_load_dwordx4 v252, s[28:31], s53 offen sc1 lds
  s_waitcnt vmcnt(11)
  s_barrier
  s_add_u32 s101, s35, 20
  s_sub_u32 s3, s101, 21
  s_cselect_b32 s101, s101, s3
  s_mul_i32 s101, s101, 0x2000
  s_add_u32 s101, s101, s62
  s_add_u32 m0, s52, 0x6000
s_nop 0
  buffer_load_dwordx4 v252, s[28:31], s101 offen sc1 lds
  s_add_u32 m0, s52, 0x7000
  s_add_u32 s53, s101, 0x1000
  buffer_load_dwordx4 v252, s[28:31], s53 offen sc1 lds
  s_add_u32 m0, s52, 0x22000
  s_add_u32 s53, s62, 0x2a000
  buffer_load_dwordx4 v252, s[28:31], s53 offen sc1 lds
  s_waitcnt vmcnt(12)
  s_barrier
  s_waitcnt vmcnt(10)
  s_barrier
  s_waitcnt vmcnt(7)
  v_cmp_eq_u32 vcc, s66, v246
s_nop 0
  s_cmp_eq_u64 vcc, exec
  s_cbranch_scc1 Lok_29
  s_mov_b32 s59, 0
Lpoll_30:
  buffer_load_dword v246, v239, s[28:31], s56 offen sc1
  s_waitcnt vmcnt(0)
  v_cmp_eq_u32 vcc, s66, v246
  s_add_u32 s59, s59, 1
  s_cmp_eq_u64 vcc, exec
  s_cbranch_scc1 Lpollok_31
  s_cmp_lt_u32 s59, 0x40000
  s_cbranch_scc1 Lpoll_30
Lpollok_31:
Lok_29:
  s_mul_i32 s55, s49, 270336
  s_add_u32 m0, s52, 0x18000
  s_add_u32 s53, s55, 0xbe0000
  buffer_load_dwordx4 v240, s[28:31], s53 offen sc1 lds
  s_add_u32 m0, s52, 0x19000
  s_add_u32 s53, s55, 0xc01000
  buffer_load_dwordx4 v240, s[28:31], s53 offen sc1 lds
  s_barrier
  s_waitcnt vmcnt(7)
  s_barrier
  s_waitcnt vmcnt(5)
  s_barrier
  s_waitcnt vmcnt(3)
  s_waitcnt vmcnt(2)
  s_barrier
  s_waitcnt vmcnt(0)
  s_barrier
  s_or_b32 s3, s2, s51
  s_cbranch_scc1 Lep_32
  v_mov_b32 v246, s65
  s_mov_b32 s3, 0xe22000
  s_mov_b64 exec, 1
  buffer_store_dword v246, off, s[28:31], s3 sc1
  s_mov_b64 exec, -1
Lep_32:
  s_endpgm
LA_START:
  s_sub_u32 s51, s51, 4
  s_setprio 1
  s_getpc_b64 s[66:67]
LPC:
  s_sub_u32 s66, s66, LPC-recurrent_scan__spectral_fnet__mixer_s_mlp__prompt_kernel
  s_subb_u32 s67, s67, 0
  s_lshl_b32 s3, s55, 2
  s_add_u32 s3, s3, s51
  s_lshl_b32 s3, s3, 10
  v_lshl_add_u32 v255, v0, 4, s3
  v_min_u32 v255, LCODE_END-recurrent_scan__spectral_fnet__mixer_s_mlp__prompt_kernel-16, v255
  s_cmp_ge_u32 s3, LCODE_END-recurrent_scan__spectral_fnet__mixer_s_mlp__prompt_kernel
  s_cbranch_scc1 Lpf_33
  global_load_dwordx4 v[4:7], v255, s[66:67]
Lpf_33:
  v_lshlrev_b32 v249, 4, v0
  s_sub_u32 s3, 63, s51
  s_cmp_gt_i32 s50, 0
  s_cselect_b32 s57, s3, s51
  s_lshl_b32 s3, s57, 10
  s_add_u32 s56, s3, s61
  v_and_b32 v248, 15, v0
  v_lshrrev_b32 v247, 4, v0
  s_lshl_b32 s3, s49, 2
  s_add_u32 s3, s3, s51
  s_lshl_b32 s3, s3, 3
  s_add_u32 s3, s3, 1
  v_and_b32 v246, 7, v0
  v_add_u32 v246, s3, v246
  v_cvt_f32_u32 v243, v246
  v_lshlrev_b32 v244, 31, v246
  v_or_b32 v244, 1.0, v244
  v_mul_f32 v251, 0x3b000000, v243
  v_mul_f32 v250, 0x3d480000, v243
  v_bfe_u32 v246, v0, 3, 1
  v_cvt_f32_u32 v246, v246
  v_mul_f32 v246, 0x3e800000, v246
  v_lshlrev_b32 v243, 3, v247
  s_lshl_b32 s3, s33, 6
  v_add_u32 v243, s3, v243
  v_cvt_f32_u32 v243, v243
  v_fma_f32 v252, v243, v251, v246
  v_fract_f32 v252, v252
  v_cos_f32 v246, v252
  v_add_f32 v252, v252, v251
  v_cos_f32 v243, v252
  v_add_f32 v252, v252, v251
  v_cvt_pk_bf16_f32 v12, v246, v243
  v_cos_f32 v246, v252
  v_add_f32 v252, v252, v251
  v_cos_f32 v243, v252
  v_add_f32 v252, v252, v251
  v_cvt_pk_bf16_f32 v13, v246, v243
  v_cos_f32 v246, v252
  v_add_f32 v252, v252, v251
  v_cos_f32 v243, v252
  v_add_f32 v252, v252, v251
  v_cvt_pk_bf16_f32 v14, v246, v243
  v_cos_f32 v246, v252
  v_add_f32 v252, v252, v251
  v_cos_f32 v243, v252
  v_add_f32 v252, v252, v250
  v_cvt_pk_bf16_f32 v15, v246, v243
  v_cos_f32 v246, v252
  v_add_f32 v252, v252, v251
  v_cos_f32 v243, v252
  v_add_f32 v252, v252, v251
  v_cvt_pk_bf16_f32 v16, v246, v243
  v_cos_f32 v246, v252
  v_add_f32 v252, v252, v251
  v_cos_f32 v243, v252
  v_add_f32 v252, v252, v251
  v_cvt_pk_bf16_f32 v17, v246, v243
  v_cos_f32 v246, v252
  v_add_f32 v252, v252, v251
  v_cos_f32 v243, v252
  v_add_f32 v252, v252, v251
  v_cvt_pk_bf16_f32 v18, v246, v243
  v_cos_f32 v246, v252
  v_add_f32 v252, v252, v251
  v_cos_f32 v243, v252
  v_add_f32 v252, v252, v250
  v_cvt_pk_bf16_f32 v19, v246, v243
  s_waitcnt lgkmcnt(0)
  buffer_load_dwordx4 v[8:11], v249, s[4:7], s56 offen
  s_add_u32 s44, s28, 0xe22000
  s_addc_u32 s45, s29, 0
  s_load_dword s65, s[44:45], 0
  s_mov_b32 s8, s36
  s_mov_b32 s9, s37
  s_mov_b32 s10, 0x80000
  s_mov_b32 s11, 0x20000
  s_mov_b32 s12, s38
  s_mov_b32 s13, s39
  s_mov_b32 s14, 0x80000
  s_mov_b32 s15, 0x20000
  s_mov_b32 s16, s40
  s_mov_b32 s17, s41
  s_mov_b32 s18, 0x158000
  s_mov_b32 s19, 0x20000
  s_mov_b32 s20, s42
  s_mov_b32 s21, s43
  s_mov_b32 s22, 0x158000
  s_mov_b32 s23, 0x20000
  s_mul_i32 s62, s48, 0x2c000
  s_add_u32 s62, s62, 0x400000
  s_cmp_ge_u32 s51, 2
  s_cbranch_scc1 Lc3_35
  s_lshl_b32 s3, s55, 4
  v_and_b32 v242, 15, v0
  v_add_u32 v242, s3, v242
  v_lshlrev_b32 v242, 10, v242
  s_mov_b64 exec, 0xffff
  s_cmp_lg_u32 s51, 0
  s_cbranch_scc1 Lc3_34
  buffer_load_dword v242, v242, s[8:11], 0 offen offset:384
  s_branch Lc3_35
Lc3_34:
  buffer_load_dword v242, v242, s[12:15], 0 offen offset:384
Lc3_35:
  s_mov_b64 exec, -1
  v_cos_f32 v246, v252
  v_add_f32 v252, v252, v251
  v_cos_f32 v243, v252
  v_add_f32 v252, v252, v251
  v_cvt_pk_bf16_f32 v20, v246, v243
  v_cos_f32 v246, v252
  v_add_f32 v252, v252, v251
  v_cos_f32 v243, v252
  v_add_f32 v252, v252, v251
  v_cvt_pk_bf16_f32 v21, v246, v243
  v_cos_f32 v246, v252
  v_add_f32 v252, v252, v251
  v_cos_f32 v243, v252
  v_add_f32 v252, v252, v251
  v_cvt_pk_bf16_f32 v22, v246, v243
  v_cos_f32 v246, v252
  v_add_f32 v252, v252, v251
  v_cos_f32 v243, v252
  v_add_f32 v252, v252, v250
  v_cvt_pk_bf16_f32 v23, v246, v243
  v_cos_f32 v246, v252
  v_add_f32 v252, v252, v251
  v_cos_f32 v243, v252
  v_add_f32 v252, v252, v251
  v_cvt_pk_bf16_f32 v24, v246, v243
  v_cos_f32 v246, v252
  v_add_f32 v252, v252, v251
  v_cos_f32 v243, v252
  v_add_f32 v252, v252, v251
  v_cvt_pk_bf16_f32 v25, v246, v243
  v_cos_f32 v246, v252
  v_add_f32 v252, v252, v251
  v_cos_f32 v243, v252
  v_add_f32 v252, v252, v251
  v_cvt_pk_bf16_f32 v26, v246, v243
  v_cos_f32 v246, v252
  v_add_f32 v252, v252, v251
  v_cos_f32 v243, v252
  v_add_f32 v252, v252, v250
  v_cvt_pk_bf16_f32 v27, v246, v243
  v_cos_f32 v246, v252
  v_add_f32 v252, v252, v251
  v_cos_f32 v243, v252
  v_add_f32 v252, v252, v251
  v_cvt_pk_bf16_f32 v28, v246, v243
  v_cos_f32 v246, v252
  v_add_f32 v252, v252, v251
  v_cos_f32 v243, v252
  v_add_f32 v252, v252, v251
  v_cvt_pk_bf16_f32 v29, v246, v243
  v_cos_f32 v246, v252
  v_add_f32 v252, v252, v251
  v_cos_f32 v243, v252
  v_add_f32 v252, v252, v251
  v_cvt_pk_bf16_f32 v30, v246, v243
  v_cos_f32 v246, v252
  v_add_f32 v252, v252, v251
  v_cos_f32 v243, v252
  v_add_f32 v252, v252, v250
  v_cvt_pk_bf16_f32 v31, v246, v243
  v_cos_f32 v246, v252
  v_add_f32 v252, v252, v251
  v_cos_f32 v243, v252
  v_add_f32 v252, v252, v251
  v_cvt_pk_bf16_f32 v32, v246, v243
  v_cos_f32 v246, v252
  v_add_f32 v252, v252, v251
  v_cos_f32 v243, v252
  v_add_f32 v252, v252, v251
  v_cvt_pk_bf16_f32 v33, v246, v243
  v_cos_f32 v246, v252
  v_add_f32 v252, v252, v251
  v_cos_f32 v243, v252
  v_add_f32 v252, v252, v251
  v_cvt_pk_bf16_f32 v34, v246, v243
  v_cos_f32 v246, v252
  v_add_f32 v252, v252, v251
  v_cos_f32 v243, v252
  v_add_f32 v252, v252, v250
  v_cvt_pk_bf16_f32 v35, v246, v243
  v_cos_f32 v246, v252
  v_add_f32 v252, v252, v251
  v_cos_f32 v243, v252
  v_add_f32 v252, v252, v251
  v_cvt_pk_bf16_f32 v36, v246, v243
  v_cos_f32 v246, v252
  v_add_f32 v252, v252, v251
  v_cos_f32 v243, v252
  v_add_f32 v252, v252, v251
  v_cvt_pk_bf16_f32 v37, v246, v243
  v_cos_f32 v246, v252
  v_add_f32 v252, v252, v251
  v_cos_f32 v243, v252
  v_add_f32 v252, v252, v251
  v_cvt_pk_bf16_f32 v38, v246, v243
  v_cos_f32 v246, v252
  v_add_f32 v252, v252, v251
  v_cos_f32 v243, v252
  v_add_f32 v252, v252, v250
  v_cvt_pk_bf16_f32 v39, v246, v243
  v_cos_f32 v246, v252
  v_add_f32 v252, v252, v251
  v_cos_f32 v243, v252
  v_add_f32 v252, v252, v251
  v_cvt_pk_bf16_f32 v40, v246, v243
  v_cos_f32 v246, v252
  v_add_f32 v252, v252, v251
  v_cos_f32 v243, v252
  v_add_f32 v252, v252, v251
  v_cvt_pk_bf16_f32 v41, v246, v243
  v_cos_f32 v246, v252
  v_add_f32 v252, v252, v251
  v_cos_f32 v243, v252
  v_add_f32 v252, v252, v251
  v_cvt_pk_bf16_f32 v42, v246, v243
  v_cos_f32 v246, v252
  v_add_f32 v252, v252, v251
  v_cos_f32 v243, v252
  v_add_f32 v252, v252, v250
  v_cvt_pk_bf16_f32 v43, v246, v243
  s_and_b32 s52, s51, 1
  s_lshr_b32 s60, s51, 1
  v_lshrrev_b32 v255, 1, v248
  v_xor_b32 v255, v255, v247
  v_lshlrev_b32 v255, 4, v255
  v_lshl_add_u32 v255, v248, 7, v255
  v_add_u32 v246, 0x6000, v255
  v_xor_b32 v241, 64, v246
  v_add_u32 v243, 0x10000, v246
  v_add_u32 v240, 0x10000, v241
  s_lshl_b32 s3, s51, 11
  v_add_u32 v239, s3, v246
  v_add_u32 v238, s3, v243
  v_add_u32 v237, s3, v241
  v_add_u32 v236, s3, v240
  s_lshl_b32 s3, s52, 5
  v_and_b32 v235, 31, v0
  v_add_u32 v235, s3, v235
  v_lshrrev_b32 v234, 5, v0
  v_bfe_u32 v255, v235, 1, 3
  v_xor_b32 v255, v255, v234
  v_lshlrev_b32 v255, 4, v255
  v_lshl_add_u32 v255, v235, 7, v255
  v_add_u32 v233, 0x6000, v255
  v_xor_b32 v231, 0x20, v233
  v_xor_b32 v229, 0x40, v233
  v_xor_b32 v227, 0x60, v233
  v_add_u32 v232, 0x10000, v233
  v_add_u32 v230, 0x10000, v231
  v_add_u32 v228, 0x10000, v229
  v_add_u32 v226, 0x10000, v227
  v_bfe_u32 v225, v0, 3, 1
  v_bfe_u32 v255, v0, 2, 2
  v_lshl_add_u32 v224, v234, 3, v255
  v_bfe_u32 v255, v0, 4, 1
  v_and_b32 v253, 1, v0
  v_lshl_add_u32 v255, v255, 1, v253
  v_lshlrev_b32 v255, 4, v255
  v_bfe_u32 v253, v0, 1, 1
  v_lshl_add_u32 v223, v253, 3, v255
  v_xor_b32 v255, s60, v225
  v_lshl_add_u32 v255, v255, 6, v223
  v_lshl_add_u32 v222, v224, 7, v255
  s_lshl_b32 s3, s52, 10
  v_add_u32 v219, s3, v249
  v_add_u32 v221, 0x10000, v222
  v_add_u32 v218, 0x10000, v219
  v_add_u32 v220, 0x20000, v222
  v_add_u32 v217, 0x20000, v219
  v_mov_b32 v216, 0x3f803f80
  v_and_b32 v215, 31, v0
  v_lshlrev_b32 v215, 2, v215
  v_and_b32 v255, 1, v247
  v_lshlrev_b32 v255, 2, v255
  v_cmp_eq_u32 vcc, v255, v248
s_nop 1
  v_cndmask_b32 v44, 0, v216, vcc
  v_mov_b32 v45, v44
  v_mov_b32 v46, v44
  v_mov_b32 v47, v44
  v_mov_b32 v210, 0
  v_mov_b32 v209, 0
  v_mov_b32 v56, v216
  v_mov_b32 v57, v216
  v_mov_b32 v58, v216
  v_mov_b32 v59, v216
  s_mov_b32 s38, 0xaaaaaaaa
  s_mov_b32 s39, s38
  s_mov_b32 s40, 0xcccccccc
  s_mov_b32 s41, s40
  s_mov_b32 s42, 0x00f0000f
  s_mov_b32 s43, 0xf0000f00
  s_lshl_b32 s3, s51, 6
  v_lshl_add_u32 v251, v248, 2, s3
  v_add_u32 v251, 0x27800, v251
  s_lshl_b32 s3, s50, 2
  s_sub_u32 s3, s3, 776
  v_subrev_u32 v250, s3, v251
  v_lshlrev_b32 v253, 2, v235
  v_add_u32 v253, 0x27800, v253
  s_waitcnt lgkmcnt(0)
  s_add_u32 s65, s65, 0x9e3779b9
  s_barrier
  ds_read_b128 v[160:163], v239 offset:0
  ds_read_b128 v[164:167], v237 offset:0
  ds_read_b128 v[168:171], v239 offset:16384
  ds_read_b128 v[172:175], v237 offset:16384
  s_barrier
  s_waitcnt lgkmcnt(3)
  v_mfma_f32_16x16x32_bf16 v[48:51], v[160:163], v[56:59], 0
  ds_read_b128 v[80:83], v233 offset:0
  v_mfma_f32_16x16x32_bf16 v[52:55], v[160:163], v[160:163], 0
  ds_read_b64_tr_b16 v[76:77], v221 offset:0
  ds_read_b64_tr_b16 v[78:79], v221 offset:512
  s_waitcnt lgkmcnt(5)
  v_mfma_f32_16x16x32_bf16 v[48:51], v[164:167], v[56:59], v[48:51]
  ds_read_b128 v[88:91], v231 offset:0
  v_mfma_f32_16x16x32_bf16 v[52:55], v[164:167], v[164:167], v[52:55]
  ds_read_b64_tr_b16 v[84:85], v221 offset:2048
  ds_read_b64_tr_b16 v[86:87], v221 offset:2560
  s_waitcnt lgkmcnt(7)
  v_mfma_f32_16x16x32_bf16 v[48:51], v[168:171], v[56:59], v[48:51]
  ds_read_b128 v[96:99], v229 offset:0
  v_mfma_f32_16x16x32_bf16 v[52:55], v[168:171], v[168:171], v[52:55]
  ds_read_b64_tr_b16 v[92:93], v221 offset:4096
  ds_read_b64_tr_b16 v[94:95], v221 offset:4608
  s_waitcnt lgkmcnt(9)
  v_mfma_f32_16x16x32_bf16 v[48:51], v[172:175], v[56:59], v[48:51]
  ds_read_b128 v[104:107], v227 offset:0
  v_mfma_f32_16x16x32_bf16 v[52:55], v[172:175], v[172:175], v[52:55]
  ds_read_b64_tr_b16 v[100:101], v221 offset:6144
  ds_read_b64_tr_b16 v[102:103], v221 offset:6656
  s_barrier
  s_waitcnt lgkmcnt(9)
  v_mfma_f32_32x32x16_bf16 v[60:75], v[76:79], v[80:83], 0
  ds_read_b128 v[160:163], v239 offset:32768
  s_waitcnt lgkmcnt(7)
  v_mfma_f32_32x32x16_bf16 v[60:75], v[84:87], v[88:91], v[60:75]
  ds_read_b128 v[164:167], v237 offset:32768
  s_waitcnt lgkmcnt(5)
  v_mfma_f32_32x32x16_bf16 v[60:75], v[92:95], v[96:99], v[60:75]
  ds_read_b128 v[168:171], v239 offset:49152
  s_waitcnt lgkmcnt(3)
  v_mfma_f32_32x32x16_bf16 v[60:75], v[100:103], v[104:107], v[60:75]
  ds_read_b128 v[172:175], v237 offset:49152
  v_mfma_f32_16x16x32_bf16 v[140:143], v[44:47], v[76:79], 0
  v_mfma_f32_16x16x32_bf16 v[140:143], v[44:47], v[84:87], v[140:143]
  v_mfma_f32_16x16x32_bf16 v[140:143], v[44:47], v[92:95], v[140:143]
  v_mfma_f32_16x16x32_bf16 v[140:143], v[44:47], v[100:103], v[140:143]
  s_barrier
  s_waitcnt lgkmcnt(3)
  v_mfma_f32_16x16x32_bf16 v[48:51], v[160:163], v[56:59], v[48:51]
  ds_read_b128 v[112:115], v233 offset:16384
  v_mfma_f32_16x16x32_bf16 v[52:55], v[160:163], v[160:163], v[52:55]
  ds_read_b64_tr_b16 v[108:109], v221 offset:16384
  ds_read_b64_tr_b16 v[110:111], v221 offset:16896
  s_waitcnt lgkmcnt(5)
  v_mfma_f32_16x16x32_bf16 v[48:51], v[164:167], v[56:59], v[48:51]
  ds_read_b128 v[120:123], v231 offset:16384
  v_mfma_f32_16x16x32_bf16 v[52:55], v[164:167], v[164:167], v[52:55]
  ds_read_b64_tr_b16 v[116:117], v221 offset:18432
  ds_read_b64_tr_b16 v[118:119], v221 offset:18944
  s_waitcnt lgkmcnt(7)
  v_mfma_f32_16x16x32_bf16 v[48:51], v[168:171], v[56:59], v[48:51]
  ds_read_b128 v[128:131], v229 offset:16384
  v_mfma_f32_16x16x32_bf16 v[52:55], v[168:171], v[168:171], v[52:55]
  ds_read_b64_tr_b16 v[124:125], v221 offset:20480
  ds_read_b64_tr_b16 v[126:127], v221 offset:20992
  s_waitcnt lgkmcnt(9)
  v_mfma_f32_16x16x32_bf16 v[48:51], v[172:175], v[56:59], v[48:51]
  ds_read_b128 v[136:139], v227 offset:16384
  v_mfma_f32_16x16x32_bf16 v[52:55], v[172:175], v[172:175], v[52:55]
  ds_read_b64_tr_b16 v[132:133], v221 offset:22528
  ds_read_b64_tr_b16 v[134:135], v221 offset:23040
  s_barrier
  s_waitcnt lgkmcnt(9)
  v_mfma_f32_32x32x16_bf16 v[60:75], v[108:111], v[112:115], v[60:75]
  ds_read_b128 v[160:163], v238 offset:0
  s_waitcnt lgkmcnt(7)
  v_mfma_f32_32x32x16_bf16 v[60:75], v[116:119], v[120:123], v[60:75]
  ds_read_b128 v[164:167], v236 offset:0
  s_waitcnt lgkmcnt(5)
  v_mfma_f32_32x32x16_bf16 v[60:75], v[124:127], v[128:131], v[60:75]
  ds_read_b128 v[168:171], v238 offset:16384
  s_waitcnt lgkmcnt(3)
  v_mfma_f32_32x32x16_bf16 v[60:75], v[132:135], v[136:139], v[60:75]
  ds_read_b128 v[172:175], v236 offset:16384
  v_mfma_f32_16x16x32_bf16 v[140:143], v[44:47], v[108:111], v[140:143]
  v_mfma_f32_16x16x32_bf16 v[140:143], v[44:47], v[116:119], v[140:143]
  v_mfma_f32_16x16x32_bf16 v[140:143], v[44:47], v[124:127], v[140:143]
  v_mfma_f32_16x16x32_bf16 v[140:143], v[44:47], v[132:135], v[140:143]
  s_barrier
  s_waitcnt lgkmcnt(3)
  v_mfma_f32_16x16x32_bf16 v[48:51], v[160:163], v[56:59], v[48:51]
  ds_read_b128 v[80:83], v233 offset:32768
  v_mfma_f32_16x16x32_bf16 v[52:55], v[160:163], v[160:163], v[52:55]
  ds_read_b64_tr_b16 v[76:77], v221 offset:32768
  ds_read_b64_tr_b16 v[78:79], v221 offset:33280
  s_waitcnt lgkmcnt(5)
  v_mfma_f32_16x16x32_bf16 v[48:51], v[164:167], v[56:59], v[48:51]
  ds_read_b128 v[88:91], v231 offset:32768
  v_mfma_f32_16x16x32_bf16 v[52:55], v[164:167], v[164:167], v[52:55]
  ds_read_b64_tr_b16 v[84:85], v221 offset:34816
  ds_read_b64_tr_b16 v[86:87], v221 offset:35328
  s_waitcnt lgkmcnt(7)
  v_mfma_f32_16x16x32_bf16 v[48:51], v[168:171], v[56:59], v[48:51]
  ds_read_b128 v[96:99], v229 offset:32768
  v_mfma_f32_16x16x32_bf16 v[52:55], v[168:171], v[168:171], v[52:55]
  ds_read_b64_tr_b16 v[92:93], v221 offset:36864
  ds_read_b64_tr_b16 v[94:95], v221 offset:37376
  s_waitcnt lgkmcnt(9)
  v_mfma_f32_16x16x32_bf16 v[48:51], v[172:175], v[56:59], v[48:51]
  ds_read_b128 v[104:107], v227 offset:32768
  v_mfma_f32_16x16x32_bf16 v[52:55], v[172:175], v[172:175], v[52:55]
  ds_read_b64_tr_b16 v[100:101], v221 offset:38912
  ds_read_b64_tr_b16 v[102:103], v221 offset:39424
  s_barrier
  s_waitcnt lgkmcnt(9)
  v_mfma_f32_32x32x16_bf16 v[60:75], v[76:79], v[80:83], v[60:75]
  ds_read_b128 v[160:163], v238 offset:32768
  s_waitcnt lgkmcnt(7)
  v_mfma_f32_32x32x16_bf16 v[60:75], v[84:87], v[88:91], v[60:75]
  ds_read_b128 v[164:167], v236 offset:32768
  s_waitcnt lgkmcnt(5)
  v_mfma_f32_32x32x16_bf16 v[60:75], v[92:95], v[96:99], v[60:75]
  ds_read_b128 v[168:171], v238 offset:40960
  s_waitcnt lgkmcnt(3)
  v_mfma_f32_32x32x16_bf16 v[60:75], v[100:103], v[104:107], v[60:75]
  ds_read_b128 v[172:175], v236 offset:40960
  v_mfma_f32_16x16x32_bf16 v[140:143], v[44:47], v[76:79], v[140:143]
  v_mfma_f32_16x16x32_bf16 v[140:143], v[44:47], v[84:87], v[140:143]
  v_mfma_f32_16x16x32_bf16 v[140:143], v[44:47], v[92:95], v[140:143]
  v_mfma_f32_16x16x32_bf16 v[140:143], v[44:47], v[100:103], v[140:143]
  s_barrier
  s_waitcnt lgkmcnt(3)
  v_mfma_f32_16x16x32_bf16 v[48:51], v[160:163], v[56:59], v[48:51]
  ds_read_b128 v[112:115], v233 offset:49152
  v_mfma_f32_16x16x32_bf16 v[52:55], v[160:163], v[160:163], v[52:55]
  ds_read_b64_tr_b16 v[108:109], v221 offset:49152
  ds_read_b64_tr_b16 v[110:111], v221 offset:49664
  s_waitcnt lgkmcnt(5)
  v_mfma_f32_16x16x32_bf16 v[48:51], v[164:167], v[56:59], v[48:51]
  ds_read_b128 v[120:123], v231 offset:49152
  v_mfma_f32_16x16x32_bf16 v[52:55], v[164:167], v[164:167], v[52:55]
  ds_read_b64_tr_b16 v[116:117], v221 offset:51200
  ds_read_b64_tr_b16 v[118:119], v221 offset:51712
  s_waitcnt lgkmcnt(7)
  v_mfma_f32_16x16x32_bf16 v[48:51], v[168:171], v[56:59], v[48:51]
  ds_read_b128 v[128:131], v229 offset:49152
  v_mfma_f32_16x16x32_bf16 v[52:55], v[168:171], v[168:171], v[52:55]
  ds_read_b64_tr_b16 v[124:125], v221 offset:53248
  ds_read_b64_tr_b16 v[126:127], v221 offset:53760
  s_waitcnt lgkmcnt(9)
  v_mfma_f32_16x16x32_bf16 v[48:51], v[172:175], v[56:59], v[48:51]
  ds_read_b128 v[136:139], v227 offset:49152
  v_mfma_f32_16x16x32_bf16 v[52:55], v[172:175], v[172:175], v[52:55]
  ds_read_b64_tr_b16 v[132:133], v221 offset:55296
  ds_read_b64_tr_b16 v[134:135], v221 offset:55808
  s_waitcnt lgkmcnt(9)
  v_mfma_f32_32x32x16_bf16 v[60:75], v[108:111], v[112:115], v[60:75]
  s_barrier
  ds_read_b128 v[80:83], v232 offset:0
  ds_read_b64_tr_b16 v[76:77], v220 offset:8192
  ds_read_b64_tr_b16 v[78:79], v220 offset:8704
  v_cndmask_b32 v48, v48, v49, s[38:39]
  v_cndmask_b32 v50, v50, v51, s[38:39]
  v_cndmask_b32 v52, v52, v53, s[38:39]
  v_cndmask_b32 v54, v54, v55, s[38:39]
  s_waitcnt lgkmcnt(9)
  v_mfma_f32_32x32x16_bf16 v[60:75], v[116:119], v[120:123], v[60:75]
  ds_read_b128 v[88:91], v230 offset:0
  ds_read_b64_tr_b16 v[84:85], v220 offset:10240
  ds_read_b64_tr_b16 v[86:87], v220 offset:10752
  v_cndmask_b32 v48, v48, v50, s[40:41]
  v_cndmask_b32 v52, v52, v54, s[40:41]
  v_mul_f32 v213, 0x3b000000, v48
  s_waitcnt lgkmcnt(9)
  v_mfma_f32_32x32x16_bf16 v[60:75], v[124:127], v[128:131], v[60:75]
  ds_read_b128 v[96:99], v228 offset:0
  ds_read_b64_tr_b16 v[92:93], v220 offset:12288
  ds_read_b64_tr_b16 v[94:95], v220 offset:12800
  v_mul_f32 v252, v213, v213
  v_fmamk_f32 v52, v52, 0xbb000000, v252
  v_max_f32 v52, -v52, 0
  s_waitcnt lgkmcnt(9)
  v_mfma_f32_32x32x16_bf16 v[60:75], v[132:135], v[136:139], v[60:75]
  ds_read_b128 v[104:107], v226 offset:0
  ds_read_b64_tr_b16 v[100:101], v220 offset:14336
  v_mfma_f32_16x16x32_bf16 v[140:143], v[44:47], v[108:111], v[140:143]
  v_mfma_f32_16x16x32_bf16 v[140:143], v[44:47], v[116:119], v[140:143]
  v_mfma_f32_16x16x32_bf16 v[140:143], v[44:47], v[124:127], v[140:143]
  v_mfma_f32_16x16x32_bf16 v[140:143], v[44:47], v[132:135], v[140:143]
  ds_read_b64_tr_b16 v[102:103], v220 offset:14848
  v_add_f32 v252, 0x3727c5ac, v52
  v_rsq_f32 v212, v252
  s_waitcnt lgkmcnt(9)
  v_mfma_f32_32x32x16_bf16 v[60:75], v[76:79], v[80:83], v[60:75]
  s_barrier
  ds_read_b128 v[112:115], v232 offset:16384
  ds_read_b64_tr_b16 v[108:109], v220 offset:16384
  ds_read_b64_tr_b16 v[110:111], v220 offset:16896
  v_mul_f32 v252, v52, v212
  v_fmaak_f32 v252, v252, v212, 0x3727c5ac
  v_rsq_f32 v252, v252
  s_waitcnt lgkmcnt(9)
  v_mfma_f32_32x32x16_bf16 v[60:75], v[84:87], v[88:91], v[60:75]
  ds_read_b128 v[120:123], v230 offset:16384
  ds_read_b64_tr_b16 v[116:117], v220 offset:18432
  ds_read_b64_tr_b16 v[118:119], v220 offset:18944
  v_mul_f32 v211, v252, v212
  s_waitcnt lgkmcnt(9)
  v_mfma_f32_32x32x16_bf16 v[60:75], v[92:95], v[96:99], v[60:75]
  ds_read_b128 v[128:131], v228 offset:16384
  ds_read_b64_tr_b16 v[124:125], v220 offset:20480
  ds_read_b64_tr_b16 v[126:127], v220 offset:20992
  s_mov_b64 exec, s[42:43]
  ds_write2_b32 v251, v213, v211 offset0:0 offset1:64
  s_mov_b64 exec, -1
  s_waitcnt lgkmcnt(10)
  v_mfma_f32_32x32x16_bf16 v[60:75], v[100:103], v[104:107], v[60:75]
  ds_read_b128 v[136:139], v226 offset:16384
  ds_read_b64_tr_b16 v[132:133], v220 offset:22528
  v_mfma_f32_16x16x32_bf16 v[140:143], v[44:47], v[76:79], v[140:143]
  v_mfma_f32_16x16x32_bf16 v[140:143], v[44:47], v[84:87], v[140:143]
  v_mfma_f32_16x16x32_bf16 v[140:143], v[44:47], v[92:95], v[140:143]
  v_mfma_f32_16x16x32_bf16 v[140:143], v[44:47], v[100:103], v[140:143]
  ds_read_b64_tr_b16 v[134:135], v220 offset:23040
  s_mov_b64 exec, s[42:43]
  ds_write_b32 v251, v212 offset:512
  s_mov_b64 exec, -1
  s_waitcnt lgkmcnt(11)
  v_mfma_f32_32x32x16_bf16 v[60:75], v[108:111], v[112:115], v[60:75]
  s_barrier
  ds_read_b128 v[80:83], v232 offset:32768
  ds_read_b64_tr_b16 v[76:77], v222 offset:0
  ds_read_b64_tr_b16 v[78:79], v222 offset:512
  s_waitcnt lgkmcnt(11)
  v_mfma_f32_32x32x16_bf16 v[60:75], v[116:119], v[120:123], v[60:75]
  ds_read_b128 v[88:91], v230 offset:32768
  ds_read_b64_tr_b16 v[84:85], v222 offset:2048
  ds_read_b64_tr_b16 v[86:87], v222 offset:2560
  s_mov_b64 exec, s[42:43]
  ds_write2_b32 v250, v213, v212 offset0:0 offset1:80
  s_mov_b64 exec, -1
  s_waitcnt lgkmcnt(11)
  v_mfma_f32_32x32x16_bf16 v[60:75], v[124:127], v[128:131], v[60:75]
  ds_read_b128 v[96:99], v228 offset:32768
  ds_read_b64_tr_b16 v[92:93], v222 offset:4096
  ds_read_b64_tr_b16 v[94:95], v222 offset:4608
  s_waitcnt lgkmcnt(10)
  v_mfma_f32_32x32x16_bf16 v[60:75], v[132:135], v[136:139], v[60:75]
  ds_read_b128 v[104:107], v226 offset:32768
  ds_read_b64_tr_b16 v[100:101], v222 offset:6144
  v_mfma_f32_16x16x32_bf16 v[140:143], v[44:47], v[108:111], v[140:143]
  v_mfma_f32_16x16x32_bf16 v[140:143], v[44:47], v[116:119], v[140:143]
  v_mfma_f32_16x16x32_bf16 v[140:143], v[44:47], v[124:127], v[140:143]
  v_mfma_f32_16x16x32_bf16 v[140:143], v[44:47], v[132:135], v[140:143]
  ds_read_b64_tr_b16 v[102:103], v222 offset:6656
  s_waitcnt lgkmcnt(10)
  v_mfma_f32_32x32x16_bf16 v[60:75], v[76:79], v[80:83], v[60:75]
  s_barrier
  ds_read_b128 v[112:115], v232 offset:40960
  ds_read_b64_tr_b16 v[108:109], v222 offset:8192
  ds_read_b64_tr_b16 v[110:111], v222 offset:8704
  ds_read2_b32 v[202:203], v253 offset0:0 offset1:64
  s_waitcnt lgkmcnt(10)
  v_mfma_f32_32x32x16_bf16 v[60:75], v[84:87], v[88:91], v[60:75]
  ds_read_b128 v[120:123], v230 offset:40960
  ds_read_b64_tr_b16 v[116:117], v222 offset:10240
  ds_read_b64_tr_b16 v[118:119], v222 offset:10752
  s_waitcnt lgkmcnt(10)
  v_mfma_f32_32x32x16_bf16 v[60:75], v[92:95], v[96:99], v[60:75]
  ds_read_b128 v[128:131], v228 offset:40960
  ds_read_b64_tr_b16 v[124:125], v222 offset:12288
  ds_read_b64_tr_b16 v[126:127], v222 offset:12800
  s_waitcnt lgkmcnt(10)
  v_mfma_f32_32x32x16_bf16 v[60:75], v[100:103], v[104:107], v[60:75]
  ds_read_b128 v[136:139], v226 offset:40960
  ds_read_b64_tr_b16 v[132:133], v222 offset:14336
  v_mfma_f32_16x16x32_bf16 v[140:143], v[44:47], v[76:79], v[140:143]
  v_mfma_f32_16x16x32_bf16 v[140:143], v[44:47], v[84:87], v[140:143]
  v_mfma_f32_16x16x32_bf16 v[140:143], v[44:47], v[92:95], v[140:143]
  v_mfma_f32_16x16x32_bf16 v[140:143], v[44:47], v[100:103], v[140:143]
  ds_read_b64_tr_b16 v[134:135], v222 offset:14848
  s_waitcnt lgkmcnt(9)
  v_mfma_f32_32x32x16_bf16 v[60:75], v[108:111], v[112:115], v[60:75]
  v_cvt_pk_bf16_f32 v176, -v202, -v202
  v_and_b32 v255, 0xffff0000, v176
  v_sub_f32 v255, -v202, v255
  v_cvt_pk_bf16_f32 v177, v255, v255
  v_mov_b32 v178, 0
  v_mov_b32 v179, 0
  v_mov_b32 v182, 0
  v_mov_b32 v183, 0
  s_waitcnt lgkmcnt(6)
  v_mfma_f32_32x32x16_bf16 v[60:75], v[116:119], v[120:123], v[60:75]
  v_mul_f32 v255, v203, v203
  v_mul_f32 v207, 0xc0135761, v203
  v_mul_f32 v255, 0x3d372713, v255
  v_mul_f32 v206, v255, v207
  v_rcp_f32 v204, v203
  s_waitcnt lgkmcnt(3)
  v_mfma_f32_32x32x16_bf16 v[60:75], v[124:127], v[128:131], v[60:75]
  s_waitcnt lgkmcnt(0)
  s_barrier
  v_mfma_f32_16x16x32_bf16 v[140:143], v[44:47], v[108:111], v[140:143]
  v_mfma_f32_16x16x32_bf16 v[140:143], v[44:47], v[116:119], v[140:143]
  v_mfma_f32_16x16x32_bf16 v[140:143], v[44:47], v[124:127], v[140:143]
  v_mfma_f32_16x16x32_bf16 v[140:143], v[44:47], v[132:135], v[140:143]
  v_mfma_f32_32x32x16_bf16 v[60:75], v[132:135], v[136:139], v[60:75]
  s_lshl_b32 s3, s49, 1
  s_add_u32 s3, s3, s60
  s_lshl_b32 s3, s3, 2
  s_add_u32 s3, s3, s52
  s_lshl_b32 s3, s3, 10
  s_add_u32 s64, s3, s61
s_nop 0
  v_cvt_pk_bf16_f32 v255, v140, v140
  v_lshlrev_b32 v255, 16, v255
  v_sub_f32 v255, v140, v255
  v_cvt_pk_bf16_f32 v180, v140, v255
  v_mov_b32 v181, v180
s_nop 1
  v_mfma_f32_32x32x16_bf16 v[60:75], v[180:183], v[176:179], v[60:75]
s_nop 11
  v_pk_mul_f32 v[184:185], v[60:61], v[60:61]
  v_pk_mul_f32 v[186:187], v[62:63], v[62:63]
  v_pk_mul_f32 v[188:189], v[64:65], v[64:65]
  v_pk_mul_f32 v[190:191], v[66:67], v[66:67]
  v_pk_fma_f32 v[184:185], v[184:185], v[206:207], v[206:207] op_sel:[0,0,1] op_sel_hi:[1,0,1]
  v_pk_fma_f32 v[186:187], v[186:187], v[206:207], v[206:207] op_sel:[0,0,1] op_sel_hi:[1,0,1]
  v_pk_fma_f32 v[188:189], v[188:189], v[206:207], v[206:207] op_sel:[0,0,1] op_sel_hi:[1,0,1]
  v_pk_fma_f32 v[190:191], v[190:191], v[206:207], v[206:207] op_sel:[0,0,1] op_sel_hi:[1,0,1]
  v_pk_mul_f32 v[184:185], v[184:185], v[60:61]
  v_pk_mul_f32 v[186:187], v[186:187], v[62:63]
  v_pk_mul_f32 v[188:189], v[188:189], v[64:65]
  v_pk_mul_f32 v[190:191], v[190:191], v[66:67]
  v_exp_f32 v184, v184
  v_exp_f32 v185, v185
  v_exp_f32 v186, v186
  v_exp_f32 v187, v187
  v_exp_f32 v188, v188
  v_exp_f32 v189, v189
  v_exp_f32 v190, v190
  v_exp_f32 v191, v191
  v_pk_fma_f32 v[184:185], v[184:185], v[204:205], v[204:205] op_sel_hi:[1,0,0]
  v_pk_fma_f32 v[186:187], v[186:187], v[204:205], v[204:205] op_sel_hi:[1,0,0]
  v_pk_fma_f32 v[188:189], v[188:189], v[204:205], v[204:205] op_sel_hi:[1,0,0]
  v_pk_fma_f32 v[190:191], v[190:191], v[204:205], v[204:205] op_sel_hi:[1,0,0]
  v_rcp_f32 v184, v184
  v_rcp_f32 v185, v185
  v_rcp_f32 v186, v186
  v_rcp_f32 v187, v187
  v_rcp_f32 v188, v188
  v_rcp_f32 v189, v189
  v_rcp_f32 v190, v190
  v_rcp_f32 v191, v191
  v_pk_mul_f32 v[184:185], v[184:185], v[60:61]
  v_pk_mul_f32 v[186:187], v[186:187], v[62:63]
  v_pk_mul_f32 v[188:189], v[188:189], v[64:65]
  v_pk_mul_f32 v[190:191], v[190:191], v[66:67]
  v_cvt_pk_bf16_f32 v44, v184, v185
  v_cvt_pk_bf16_f32 v45, v186, v187
  v_cvt_pk_bf16_f32 v46, v188, v189
  v_cvt_pk_bf16_f32 v47, v190, v191
  v_pk_mul_f32 v[184:185], v[68:69], v[68:69]
  v_pk_mul_f32 v[186:187], v[70:71], v[70:71]
  v_pk_mul_f32 v[188:189], v[72:73], v[72:73]
  v_pk_mul_f32 v[190:191], v[74:75], v[74:75]
  v_pk_fma_f32 v[184:185], v[184:185], v[206:207], v[206:207] op_sel:[0,0,1] op_sel_hi:[1,0,1]
  v_pk_fma_f32 v[186:187], v[186:187], v[206:207], v[206:207] op_sel:[0,0,1] op_sel_hi:[1,0,1]
  v_pk_fma_f32 v[188:189], v[188:189], v[206:207], v[206:207] op_sel:[0,0,1] op_sel_hi:[1,0,1]
  v_pk_fma_f32 v[190:191], v[190:191], v[206:207], v[206:207] op_sel:[0,0,1] op_sel_hi:[1,0,1]
  v_pk_mul_f32 v[184:185], v[184:185], v[68:69]
  v_pk_mul_f32 v[186:187], v[186:187], v[70:71]
  v_pk_mul_f32 v[188:189], v[188:189], v[72:73]
  v_pk_mul_f32 v[190:191], v[190:191], v[74:75]
  v_exp_f32 v184, v184
  v_exp_f32 v185, v185
  v_exp_f32 v186, v186
  v_exp_f32 v187, v187
  v_exp_f32 v188, v188
  v_exp_f32 v189, v189
  v_exp_f32 v190, v190
  v_exp_f32 v191, v191
  v_pk_fma_f32 v[184:185], v[184:185], v[204:205], v[204:205] op_sel_hi:[1,0,0]
  v_pk_fma_f32 v[186:187], v[186:187], v[204:205], v[204:205] op_sel_hi:[1,0,0]
  v_pk_fma_f32 v[188:189], v[188:189], v[204:205], v[204:205] op_sel_hi:[1,0,0]
  v_pk_fma_f32 v[190:191], v[190:191], v[204:205], v[204:205] op_sel_hi:[1,0,0]
  v_rcp_f32 v184, v184
  v_rcp_f32 v185, v185
  v_rcp_f32 v186, v186
  v_rcp_f32 v187, v187
  v_rcp_f32 v188, v188
  v_rcp_f32 v189, v189
  v_rcp_f32 v190, v190
  v_rcp_f32 v191, v191
  v_pk_mul_f32 v[184:185], v[184:185], v[68:69]
  v_pk_mul_f32 v[186:187], v[186:187], v[70:71]
  v_pk_mul_f32 v[188:189], v[188:189], v[72:73]
  v_pk_mul_f32 v[190:191], v[190:191], v[74:75]
  v_cvt_pk_bf16_f32 v48, v184, v185
  v_cvt_pk_bf16_f32 v49, v186, v187
  v_cvt_pk_bf16_f32 v50, v188, v189
  v_cvt_pk_bf16_f32 v51, v190, v191
  s_add_u32 s3, s48, 1
  s_and_b32 s3, s3, 30
  s_cbranch_scc1 Ledge_36
  s_lshl_b32 s3, s48, 6
  s_sub_u32 s3, s3, s50
  v_add_u32 v255, s3, v235
  v_cmp_gt_u32 vcc, 0x800, v255
s_nop 1
  v_cndmask_b32 v44, 0, v44, vcc
  v_cndmask_b32 v45, 0, v45, vcc
  v_cndmask_b32 v46, 0, v46, vcc
  v_cndmask_b32 v47, 0, v47, vcc
  v_cndmask_b32 v48, 0, v48, vcc
  v_cndmask_b32 v49, 0, v49, vcc
  v_cndmask_b32 v50, 0, v50, vcc
  v_cndmask_b32 v51, 0, v51, vcc
Ledge_36:
  buffer_store_dwordx4 v[44:47], v249, s[28:31], s64 offen offset:0 sc1
  buffer_store_dwordx4 v[48:51], v249, s[28:31], s64 offen offset:2048 sc1
  ds_read_b128 v[108:111], v246 offset:0
  ds_read_b128 v[112:115], v246 offset:2048
  ds_read_b128 v[116:119], v246 offset:4096
  ds_read_b128 v[120:123], v246 offset:6144
  ds_read_b128 v[124:127], v241 offset:0
  ds_read_b128 v[128:131], v241 offset:2048
  ds_read_b128 v[132:135], v241 offset:4096
  ds_read_b128 v[136:139], v241 offset:6144
  s_lshl_b32 s3, s60, 6
  v_subrev_u32 v255, 0x6000, v233
  v_xor_b32 v255, s3, v255
  v_xor_b32 v254, 32, v255
  ds_read_b128 v[144:147], v255 offset:16384
  ds_read_b128 v[148:151], v254 offset:16384
  s_waitcnt vmcnt(2)
  v_dot2c_f32_bf16 v210, v216, v8
  v_dot2c_f32_bf16 v209, v8, v8
  v_dot2c_f32_bf16 v210, v216, v9
  v_dot2c_f32_bf16 v209, v9, v9
  v_dot2c_f32_bf16 v210, v216, v10
  v_dot2c_f32_bf16 v209, v10, v10
  v_dot2c_f32_bf16 v210, v216, v11
  v_dot2c_f32_bf16 v209, v11, v11
  s_waitcnt lgkmcnt(6)
  v_mfma_f32_16x16x32_bf16 v[76:79], v[108:111], v[12:15], 0
  ds_read_b128 v[160:163], v246 offset:16384
  v_mfma_f32_16x16x32_bf16 v[80:83], v[112:115], v[12:15], 0
  ds_read_b128 v[164:167], v246 offset:18432
  v_mfma_f32_16x16x32_bf16 v[84:87], v[116:119], v[12:15], 0
  ds_read_b128 v[168:171], v246 offset:20480
  v_mfma_f32_16x16x32_bf16 v[88:91], v[120:123], v[12:15], 0
  ds_read_b128 v[172:175], v246 offset:22528
  v_permlane32_swap_b32 v210, v209
  v_add_f32 v210, v210, v209
  v_mov_b32 v209, v210
s_nop 1
  v_permlane16_swap_b32 v210, v209
  v_add_f32 v210, v210, v209
  s_waitcnt lgkmcnt(4)
  v_mfma_f32_16x16x32_bf16 v[76:79], v[124:127], v[16:19], v[76:79]
  ds_read_b128 v[108:111], v241 offset:16384
  v_mfma_f32_16x16x32_bf16 v[80:83], v[128:131], v[16:19], v[80:83]
  ds_read_b128 v[112:115], v241 offset:18432
  v_mfma_f32_16x16x32_bf16 v[84:87], v[132:135], v[16:19], v[84:87]
  ds_read_b128 v[116:119], v241 offset:20480
  v_mfma_f32_16x16x32_bf16 v[88:91], v[136:139], v[16:19], v[88:91]
  ds_read_b128 v[120:123], v241 offset:22528
  v_add_f32_dpp v210, v210, v210 row_ror:8 row_mask:0xf bank_mask:0xf
s_nop 1
  v_add_f32_dpp v210, v210, v210 row_ror:4 row_mask:0xf bank_mask:0xf
s_nop 1
  v_add_f32_dpp v210, v210, v210 row_ror:2 row_mask:0xf bank_mask:0xf
s_nop 1
  v_add_f32_dpp v210, v210, v210 row_ror:1 row_mask:0xf bank_mask:0xf
  v_mov_b32 v209, v210
s_nop 1
  v_permlane32_swap_b32 v210, v209
  s_waitcnt lgkmcnt(4)
  v_mfma_f32_16x16x32_bf16 v[76:79], v[160:163], v[20:23], v[76:79]
  ds_read_b128 v[124:127], v246 offset:32768
  v_mfma_f32_16x16x32_bf16 v[80:83], v[164:167], v[20:23], v[80:83]
  ds_read_b128 v[128:131], v246 offset:34816
  v_mfma_f32_16x16x32_bf16 v[84:87], v[168:171], v[20:23], v[84:87]
  ds_read_b128 v[132:135], v246 offset:36864
  v_mfma_f32_16x16x32_bf16 v[88:91], v[172:175], v[20:23], v[88:91]
  ds_read_b128 v[136:139], v246 offset:38912
  v_mul_f32 v213, 0x3b000000, v210
  v_mul_f32 v252, v213, v213
  v_fmamk_f32 v209, v209, 0xbb000000, v252
  v_max_f32 v209, -v209, 0
  v_add_f32 v252, 0x3727c5ac, v209
  v_rsq_f32 v212, v252
  s_waitcnt lgkmcnt(4)
  v_mfma_f32_16x16x32_bf16 v[76:79], v[108:111], v[24:27], v[76:79]
  ds_read_b128 v[160:163], v241 offset:32768
  v_mfma_f32_16x16x32_bf16 v[80:83], v[112:115], v[24:27], v[80:83]
  ds_read_b128 v[164:167], v241 offset:34816
  v_mfma_f32_16x16x32_bf16 v[84:87], v[116:119], v[24:27], v[84:87]
  ds_read_b128 v[168:171], v241 offset:36864
  v_mfma_f32_16x16x32_bf16 v[88:91], v[120:123], v[24:27], v[88:91]
  ds_read_b128 v[172:175], v241 offset:38912
  s_abs_i32 s3, s50
  s_add_u32 s57, s57, 2
  s_cmp_lt_u32 s51, s3
  s_cselect_b32 s3, s57, 70
  s_lshl_b32 s3, s3, 2
  s_add_u32 s3, s3, 0x27b00
  v_mov_b32 v252, s3
  ds_write_b32 v252, v213
  ds_write_b32 v252, v212 offset:320
  s_waitcnt lgkmcnt(6)
  v_mfma_f32_16x16x32_bf16 v[76:79], v[124:127], v[28:31], v[76:79]
  ds_read_b128 v[108:111], v246 offset:49152
  v_mfma_f32_16x16x32_bf16 v[80:83], v[128:131], v[28:31], v[80:83]
  ds_read_b128 v[112:115], v246 offset:51200
  v_mfma_f32_16x16x32_bf16 v[84:87], v[132:135], v[28:31], v[84:87]
  ds_read_b128 v[116:119], v246 offset:53248
  v_mfma_f32_16x16x32_bf16 v[88:91], v[136:139], v[28:31], v[88:91]
  ds_read_b128 v[120:123], v246 offset:55296
  v_lshlrev_b32 v60, 16, v144
  v_and_b32 v61, 0xffff0000, v144
  v_lshlrev_b32 v62, 16, v145
  v_and_b32 v63, 0xffff0000, v145
  s_waitcnt lgkmcnt(4)
  v_mfma_f32_16x16x32_bf16 v[76:79], v[160:163], v[32:35], v[76:79]
  ds_read_b128 v[124:127], v241 offset:49152
  v_mfma_f32_16x16x32_bf16 v[80:83], v[164:167], v[32:35], v[80:83]
  ds_read_b128 v[128:131], v241 offset:51200
  v_mfma_f32_16x16x32_bf16 v[84:87], v[168:171], v[32:35], v[84:87]
  ds_read_b128 v[132:135], v241 offset:53248
  v_mfma_f32_16x16x32_bf16 v[88:91], v[172:175], v[32:35], v[88:91]
  ds_read_b128 v[136:139], v241 offset:55296
  v_lshlrev_b32 v64, 16, v146
  v_and_b32 v65, 0xffff0000, v146
  v_lshlrev_b32 v66, 16, v147
  v_and_b32 v67, 0xffff0000, v147
  s_waitcnt lgkmcnt(4)
  v_mfma_f32_16x16x32_bf16 v[76:79], v[108:111], v[36:39], v[76:79]
  ds_read_b128 v[160:163], v243 offset:0
  v_mfma_f32_16x16x32_bf16 v[80:83], v[112:115], v[36:39], v[80:83]
  ds_read_b128 v[164:167], v243 offset:2048
  v_mfma_f32_16x16x32_bf16 v[84:87], v[116:119], v[36:39], v[84:87]
  ds_read_b128 v[168:171], v243 offset:4096
  v_mfma_f32_16x16x32_bf16 v[88:91], v[120:123], v[36:39], v[88:91]
  ds_read_b128 v[172:175], v243 offset:6144
  v_lshlrev_b32 v68, 16, v148
  v_and_b32 v69, 0xffff0000, v148
  v_lshlrev_b32 v70, 16, v149
  v_and_b32 v71, 0xffff0000, v149
  s_waitcnt lgkmcnt(4)
  v_mfma_f32_16x16x32_bf16 v[76:79], v[124:127], v[40:43], v[76:79]
  ds_read_b128 v[108:111], v240 offset:0
  v_mfma_f32_16x16x32_bf16 v[80:83], v[128:131], v[40:43], v[80:83]
  ds_read_b128 v[112:115], v240 offset:2048
  v_mfma_f32_16x16x32_bf16 v[84:87], v[132:135], v[40:43], v[84:87]
  ds_read_b128 v[116:119], v240 offset:4096
  v_mfma_f32_16x16x32_bf16 v[88:91], v[136:139], v[40:43], v[88:91]
  ds_read_b128 v[120:123], v240 offset:6144
  v_lshlrev_b32 v72, 16, v150
  v_and_b32 v73, 0xffff0000, v150
  v_lshlrev_b32 v74, 16, v151
  v_and_b32 v75, 0xffff0000, v151
  s_waitcnt lgkmcnt(4)
  v_mfma_f32_16x16x32_bf16 v[92:95], v[160:163], v[12:15], 0
  ds_read_b128 v[124:127], v243 offset:16384
  v_mfma_f32_16x16x32_bf16 v[96:99], v[164:167], v[12:15], 0
  ds_read_b128 v[128:131], v243 offset:18432
  v_mfma_f32_16x16x32_bf16 v[100:103], v[168:171], v[12:15], 0
  ds_read_b128 v[132:135], v243 offset:20480
  v_mfma_f32_16x16x32_bf16 v[104:107], v[172:175], v[12:15], 0
  ds_read_b128 v[136:139], v243 offset:22528
  s_lshl_b32 s3, s60, 2
  v_lshrrev_b32 v255, 1, v247
  v_add_u32 v255, s3, v255
  v_lshrrev_b32 v254, 1, v248
  v_xor_b32 v255, v255, v254
  v_lshlrev_b32 v255, 4, v255
  v_and_b32 v254, 1, v247
  v_lshl_add_u32 v255, v254, 3, v255
  v_lshl_add_u32 v255, v248, 7, v255
  s_lshl_b32 s3, s52, 12
  v_add_u32 v255, s3, v255
  v_xor_b32 v254, 32, v255
  ds_read_b64 v[144:145], v255 offset:16384
  ds_read_b64 v[146:147], v255 offset:18432
  ds_read_b64 v[148:149], v254 offset:16384
  ds_read_b64 v[150:151], v254 offset:18432
  s_waitcnt lgkmcnt(8)
  v_mfma_f32_16x16x32_bf16 v[92:95], v[108:111], v[16:19], v[92:95]
  ds_read_b128 v[160:163], v240 offset:16384
  v_mfma_f32_16x16x32_bf16 v[96:99], v[112:115], v[16:19], v[96:99]
  ds_read_b128 v[164:167], v240 offset:18432
  v_mfma_f32_16x16x32_bf16 v[100:103], v[116:119], v[16:19], v[100:103]
  ds_read_b128 v[168:171], v240 offset:20480
  v_mfma_f32_16x16x32_bf16 v[104:107], v[120:123], v[16:19], v[104:107]
  ds_read_b128 v[172:175], v240 offset:22528
  s_waitcnt vmcnt(0)
  s_barrier
  v_lshlrev_b32 v253, 2, v235
  v_add_u32 v253, 0x27800, v253
  ds_read_b32 v202, v253 offset:776
  ds_read_b32 v203, v253 offset:1096
  s_waitcnt lgkmcnt(6)
  v_mfma_f32_16x16x32_bf16 v[92:95], v[124:127], v[20:23], v[92:95]
  ds_read_b128 v[108:111], v243 offset:32768
  v_mfma_f32_16x16x32_bf16 v[96:99], v[128:131], v[20:23], v[96:99]
  ds_read_b128 v[112:115], v243 offset:34816
  v_mfma_f32_16x16x32_bf16 v[100:103], v[132:135], v[20:23], v[100:103]
  ds_read_b128 v[116:119], v243 offset:36864
  v_mfma_f32_16x16x32_bf16 v[104:107], v[136:139], v[20:23], v[104:107]
  ds_read_b128 v[120:123], v243 offset:38912
  s_waitcnt lgkmcnt(4)
  v_mfma_f32_16x16x32_bf16 v[92:95], v[160:163], v[24:27], v[92:95]
  ds_read_b128 v[124:127], v240 offset:32768
  v_mfma_f32_16x16x32_bf16 v[96:99], v[164:167], v[24:27], v[96:99]
  ds_read_b128 v[128:131], v240 offset:34816
  v_mfma_f32_16x16x32_bf16 v[100:103], v[168:171], v[24:27], v[100:103]
  ds_read_b128 v[132:135], v240 offset:36864
  v_mfma_f32_16x16x32_bf16 v[104:107], v[172:175], v[24:27], v[104:107]
  ds_read_b128 v[136:139], v240 offset:38912
  v_mul_f32 v202, v202, v203
  v_sub_f32 v202, 0, v202
  s_waitcnt lgkmcnt(4)
  v_mfma_f32_16x16x32_bf16 v[92:95], v[108:111], v[28:31], v[92:95]
  ds_read_b128 v[160:163], v243 offset:40960
  v_mfma_f32_16x16x32_bf16 v[96:99], v[112:115], v[28:31], v[96:99]
  ds_read_b128 v[164:167], v243 offset:43008
  v_mfma_f32_16x16x32_bf16 v[100:103], v[116:119], v[28:31], v[100:103]
  ds_read_b128 v[168:171], v243 offset:45056
  v_mfma_f32_16x16x32_bf16 v[104:107], v[120:123], v[28:31], v[104:107]
  ds_read_b128 v[172:175], v243 offset:47104
  s_waitcnt lgkmcnt(4)
  v_mfma_f32_16x16x32_bf16 v[92:95], v[124:127], v[32:35], v[92:95]
  ds_read_b128 v[108:111], v240 offset:40960
  v_mfma_f32_16x16x32_bf16 v[96:99], v[128:131], v[32:35], v[96:99]
  ds_read_b128 v[112:115], v240 offset:43008
  v_mfma_f32_16x16x32_bf16 v[100:103], v[132:135], v[32:35], v[100:103]
  ds_read_b128 v[116:119], v240 offset:45056
  v_mfma_f32_16x16x32_bf16 v[104:107], v[136:139], v[32:35], v[104:107]
  ds_read_b128 v[120:123], v240 offset:47104
  v_lshlrev_b32 v253, 4, v247
  v_add_u32 v253, 0x27a00, v253
  ds_read_b128 v[52:55], v253 offset:0
  ds_read_b128 v[56:59], v253 offset:64
  ds_read_b128 v[192:195], v253 offset:128
  ds_read_b128 v[196:199], v253 offset:192
  s_waitcnt lgkmcnt(8)
  v_mfma_f32_16x16x32_bf16 v[92:95], v[160:163], v[36:39], v[92:95]
  v_mfma_f32_16x16x32_bf16 v[96:99], v[164:167], v[36:39], v[96:99]
  v_mfma_f32_16x16x32_bf16 v[100:103], v[168:171], v[36:39], v[100:103]
  v_mfma_f32_16x16x32_bf16 v[104:107], v[172:175], v[36:39], v[104:107]
  v_fma_f32 v60, v60, v203, v202
  v_fma_f32 v61, v61, v203, v202
  v_fma_f32 v62, v62, v203, v202
  v_fma_f32 v63, v63, v203, v202
  v_fma_f32 v64, v64, v203, v202
  v_fma_f32 v65, v65, v203, v202
  v_fma_f32 v66, v66, v203, v202
  v_fma_f32 v67, v67, v203, v202
  s_waitcnt lgkmcnt(4)
  v_mfma_f32_16x16x32_bf16 v[92:95], v[108:111], v[40:43], v[92:95]
  v_mfma_f32_16x16x32_bf16 v[96:99], v[112:115], v[40:43], v[96:99]
  v_mfma_f32_16x16x32_bf16 v[100:103], v[116:119], v[40:43], v[100:103]
  v_mfma_f32_16x16x32_bf16 v[104:107], v[120:123], v[40:43], v[104:107]
  v_fma_f32 v68, v68, v203, v202
  v_fma_f32 v69, v69, v203, v202
  v_fma_f32 v70, v70, v203, v202
  v_fma_f32 v71, v71, v203, v202
  v_fma_f32 v72, v72, v203, v202
  v_fma_f32 v73, v73, v203, v202
  v_fma_f32 v74, v74, v203, v202
  v_fma_f32 v75, v75, v203, v202
  s_cmp_lg_u32 s51, 0
  s_cbranch_scc1 Lnopoll_37
  s_lshl_b32 s63, s48, 12
  s_add_u32 s63, s63, 0xe00000
  s_add_u32 s44, s28, s63
  s_addc_u32 s45, s29, 0
  s_add_u32 s34, s65, 1
  s_mov_b32 s35, s34
  s_waitcnt lgkmcnt(0)
  s_mov_b32 s59, 0
Lspoll_39:
  s_load_dwordx8 s[36:43], s[44:45], s59
  s_add_u32 s59, s59, 64
  s_waitcnt lgkmcnt(0)
  s_xor_b64 s[46:47], s[36:37], s[34:35]
  s_xor_b64 s[0:1], s[38:39], s[34:35]
  s_or_b64 s[46:47], s[46:47], s[0:1]
  s_xor_b64 s[0:1], s[40:41], s[34:35]
  s_or_b64 s[46:47], s[46:47], s[0:1]
  s_xor_b64 s[0:1], s[42:43], s[34:35]
  s_or_b64 s[46:47], s[46:47], s[0:1]
  s_cbranch_scc0 Lpollok_38
  s_cmp_lt_u32 s59, 1024
  s_cbranch_scc1 Lspoll_39
  v_and_b32 v250, 28, v215
  s_mov_b32 s59, 0
Lpoll_40:
  buffer_load_dword v255, v250, s[28:31], s63 offen sc1
  s_waitcnt vmcnt(0)
  v_cmp_eq_u32 vcc, s34, v255
  s_add_u32 s59, s59, 1
  s_cmp_eq_u64 vcc, exec
  s_cbranch_scc1 Lpollok_41
  s_cmp_lt_u32 s59, 0x40000
  s_cbranch_scc1 Lpoll_40
Lpollok_41:
Lpollok_38:
Lnopoll_37:
  s_barrier
  v_lshrrev_b32 v255, 1, v247
  v_and_b32 v254, 7, v0
  v_xor_b32 v255, v255, v254
  v_lshlrev_b32 v255, 4, v255
  v_and_b32 v253, 1, v247
  v_lshl_add_u32 v255, v253, 3, v255
  v_lshl_add_u32 v255, v248, 7, v255
  s_lshl_b32 s3, s51, 11
  v_add_u32 v255, s3, v255
  v_xor_b32 v253, 32, v255
  v_xor_b32 v252, 64, v255
  v_xor_b32 v251, 0x60, v255
  s_waitcnt lgkmcnt(0)
  v_pk_fma_f32 v[76:77], v[92:93], v[244:245], v[76:77] op_sel_hi:[1,0,1]
  v_pk_fma_f32 v[78:79], v[94:95], v[244:245], v[78:79] op_sel_hi:[1,0,1]
  v_pk_fma_f32 v[80:81], v[96:97], v[244:245], v[80:81] op_sel_hi:[1,0,1]
  v_pk_fma_f32 v[82:83], v[98:99], v[244:245], v[82:83] op_sel_hi:[1,0,1]
  v_pk_fma_f32 v[84:85], v[100:101], v[244:245], v[84:85] op_sel_hi:[1,0,1]
  v_pk_fma_f32 v[86:87], v[102:103], v[244:245], v[86:87] op_sel_hi:[1,0,1]
  v_pk_fma_f32 v[88:89], v[104:105], v[244:245], v[88:89] op_sel_hi:[1,0,1]
  v_pk_fma_f32 v[90:91], v[106:107], v[244:245], v[90:91] op_sel_hi:[1,0,1]
  v_pk_mul_f32 v[76:77], v[76:77], v[52:53]
  v_pk_mul_f32 v[78:79], v[78:79], v[54:55]
  v_pk_mul_f32 v[80:81], v[80:81], v[56:57]
  v_pk_mul_f32 v[82:83], v[82:83], v[58:59]
  v_pk_mul_f32 v[84:85], v[84:85], v[192:193]
  v_pk_mul_f32 v[86:87], v[86:87], v[194:195]
  v_pk_mul_f32 v[88:89], v[88:89], v[196:197]
  v_pk_mul_f32 v[90:91], v[90:91], v[198:199]
  v_cvt_pk_bf16_f32 v92, v76, v77
  v_cvt_pk_bf16_f32 v93, v78, v79
  v_cvt_pk_bf16_f32 v94, v80, v81
  v_cvt_pk_bf16_f32 v95, v82, v83
  v_cvt_pk_bf16_f32 v96, v84, v85
  v_cvt_pk_bf16_f32 v97, v86, v87
  v_cvt_pk_bf16_f32 v98, v88, v89
  v_cvt_pk_bf16_f32 v99, v90, v91
  ds_write_b64 v255, v[92:93] offset:16384
  ds_write_b64 v253, v[94:95] offset:16384
  ds_write_b64 v252, v[96:97] offset:16384
  ds_write_b64 v251, v[98:99] offset:16384
  v_lshrrev_b32 v250, 3, v0
  v_xor_b32 v255, v254, v250
  v_lshlrev_b32 v255, 4, v255
  v_lshl_add_u32 v255, v250, 7, v255
  v_add_u32 v255, s3, v255
  ds_read_b128 v[76:79], v255 offset:16384
  ds_read_b128 v[80:83], v255 offset:17408
  v_mul_u32_u24 v246, 0x2100, v250
  v_lshl_add_u32 v246, v254, 4, v246
  s_lshl_b32 s3, s49, 2
  s_add_u32 s3, s3, s51
  s_mul_i32 s3, s3, 67584
  s_lshl_b32 s55, s48, 7
  s_add_u32 s3, s3, s55
  s_add_u32 s32, s3, 0x9c0000
  s_add_u32 s33, s32, 4224
  s_barrier
  ds_read_b128 v[8:11], v219 offset:24576
  ds_read_b64_tr_b16 v[4:5], v222 offset:32768
  ds_read_b64_tr_b16 v[6:7], v222 offset:33280
  ds_read_b128 v[16:19], v219 offset:26624
  ds_read_b64_tr_b16 v[12:13], v222 offset:34816
  ds_read_b64_tr_b16 v[14:15], v222 offset:35328
  ds_read_b128 v[24:27], v219 offset:28672
  ds_read_b64_tr_b16 v[20:21], v222 offset:36864
  ds_read_b64_tr_b16 v[22:23], v222 offset:37376
  ds_read_b128 v[32:35], v219 offset:30720
  ds_read_b64_tr_b16 v[28:29], v222 offset:38912
  ds_read_b64_tr_b16 v[30:31], v222 offset:39424
  s_waitcnt lgkmcnt(12)
  s_waitcnt lgkmcnt(9)
  v_mfma_f32_32x32x16_bf16 v[60:75], v[4:7], v[8:11], v[60:75]
  s_barrier
  ds_read_b128 v[40:43], v219 offset:40960
  ds_read_b64_tr_b16 v[36:37], v222 offset:49152
  ds_read_b64_tr_b16 v[38:39], v222 offset:49664
  s_waitcnt lgkmcnt(9)
  v_mfma_f32_32x32x16_bf16 v[60:75], v[12:15], v[16:19], v[60:75]
  ds_read_b128 v[8:11], v219 offset:43008
  ds_read_b64_tr_b16 v[4:5], v222 offset:51200
  ds_read_b64_tr_b16 v[6:7], v222 offset:51712
  s_waitcnt lgkmcnt(9)
  v_mfma_f32_32x32x16_bf16 v[60:75], v[20:23], v[24:27], v[60:75]
  ds_read_b128 v[16:19], v219 offset:45056
  ds_read_b64_tr_b16 v[12:13], v222 offset:53248
  ds_read_b64_tr_b16 v[14:15], v222 offset:53760
  s_waitcnt lgkmcnt(9)
  v_mfma_f32_32x32x16_bf16 v[60:75], v[28:31], v[32:35], v[60:75]
  ds_read_b128 v[24:27], v219 offset:47104
  ds_read_b64_tr_b16 v[20:21], v222 offset:55296
  ds_read_b64_tr_b16 v[22:23], v222 offset:55808
  s_waitcnt lgkmcnt(9)
  v_mfma_f32_32x32x16_bf16 v[60:75], v[36:39], v[40:43], v[60:75]
  s_barrier
  ds_read_b128 v[32:35], v219 offset:57344
  ds_read_b64_tr_b16 v[28:29], v221 offset:0
  ds_read_b64_tr_b16 v[30:31], v221 offset:512
  s_waitcnt lgkmcnt(9)
  v_mfma_f32_32x32x16_bf16 v[60:75], v[4:7], v[8:11], v[60:75]
  ds_read_b128 v[40:43], v219 offset:59392
  ds_read_b64_tr_b16 v[36:37], v221 offset:2048
  ds_read_b64_tr_b16 v[38:39], v221 offset:2560
  s_waitcnt lgkmcnt(9)
  v_mfma_f32_32x32x16_bf16 v[60:75], v[12:15], v[16:19], v[60:75]
  ds_read_b128 v[8:11], v219 offset:61440
  ds_read_b64_tr_b16 v[4:5], v221 offset:4096
  ds_read_b64_tr_b16 v[6:7], v221 offset:4608
  s_waitcnt lgkmcnt(9)
  v_mfma_f32_32x32x16_bf16 v[60:75], v[20:23], v[24:27], v[60:75]
  ds_read_b128 v[16:19], v219 offset:63488
  ds_read_b64_tr_b16 v[12:13], v221 offset:6144
  ds_read_b64_tr_b16 v[14:15], v221 offset:6656
  s_waitcnt lgkmcnt(9)
  v_mfma_f32_32x32x16_bf16 v[60:75], v[28:31], v[32:35], v[60:75]
  s_barrier
  ds_read_b128 v[24:27], v218 offset:8192
  ds_read_b64_tr_b16 v[20:21], v221 offset:16384
  ds_read_b64_tr_b16 v[22:23], v221 offset:16896
  s_waitcnt lgkmcnt(9)
  v_mfma_f32_32x32x16_bf16 v[60:75], v[36:39], v[40:43], v[60:75]
  ds_read_b128 v[32:35], v218 offset:10240
  ds_read_b64_tr_b16 v[28:29], v221 offset:18432
  ds_read_b64_tr_b16 v[30:31], v221 offset:18944
  s_waitcnt lgkmcnt(9)
  v_mfma_f32_32x32x16_bf16 v[60:75], v[4:7], v[8:11], v[60:75]
  ds_read_b128 v[40:43], v218 offset:12288
  ds_read_b64_tr_b16 v[36:37], v221 offset:20480
  ds_read_b64_tr_b16 v[38:39], v221 offset:20992
  s_waitcnt lgkmcnt(9)
  v_mfma_f32_32x32x16_bf16 v[60:75], v[12:15], v[16:19], v[60:75]
  ds_read_b128 v[8:11], v218 offset:14336
  ds_read_b64_tr_b16 v[4:5], v221 offset:22528
  ds_read_b64_tr_b16 v[6:7], v221 offset:23040
  s_waitcnt lgkmcnt(9)
  v_mfma_f32_32x32x16_bf16 v[60:75], v[20:23], v[24:27], v[60:75]
  s_barrier
  ds_read_b128 v[16:19], v218 offset:24576
  ds_read_b64_tr_b16 v[12:13], v221 offset:32768
  ds_read_b64_tr_b16 v[14:15], v221 offset:33280
  s_waitcnt lgkmcnt(9)
  v_mfma_f32_32x32x16_bf16 v[60:75], v[28:31], v[32:35], v[60:75]
  ds_read_b128 v[24:27], v218 offset:26624
  ds_read_b64_tr_b16 v[20:21], v221 offset:34816
  ds_read_b64_tr_b16 v[22:23], v221 offset:35328
  s_waitcnt lgkmcnt(9)
  v_mfma_f32_32x32x16_bf16 v[60:75], v[36:39], v[40:43], v[60:75]
  ds_read_b128 v[32:35], v218 offset:28672
  ds_read_b64_tr_b16 v[28:29], v221 offset:36864
  ds_read_b64_tr_b16 v[30:31], v221 offset:37376
  s_waitcnt lgkmcnt(9)
  v_mfma_f32_32x32x16_bf16 v[60:75], v[4:7], v[8:11], v[60:75]
  ds_read_b128 v[40:43], v218 offset:30720
  ds_read_b64_tr_b16 v[36:37], v221 offset:38912
  ds_read_b64_tr_b16 v[38:39], v221 offset:39424
  s_waitcnt lgkmcnt(9)
  v_mfma_f32_32x32x16_bf16 v[60:75], v[12:15], v[16:19], v[60:75]
  s_barrier
  ds_read_b128 v[8:11], v218 offset:40960
  ds_read_b64_tr_b16 v[4:5], v221 offset:49152
  ds_read_b64_tr_b16 v[6:7], v221 offset:49664
  s_waitcnt lgkmcnt(9)
  v_mfma_f32_32x32x16_bf16 v[60:75], v[20:23], v[24:27], v[60:75]
  ds_read_b128 v[16:19], v218 offset:43008
  ds_read_b64_tr_b16 v[12:13], v221 offset:51200
  ds_read_b64_tr_b16 v[14:15], v221 offset:51712
  s_waitcnt lgkmcnt(9)
  v_mfma_f32_32x32x16_bf16 v[60:75], v[28:31], v[32:35], v[60:75]
  ds_read_b128 v[24:27], v218 offset:45056
  ds_read_b64_tr_b16 v[20:21], v221 offset:53248
  ds_read_b64_tr_b16 v[22:23], v221 offset:53760
  s_waitcnt lgkmcnt(9)
  v_mfma_f32_32x32x16_bf16 v[60:75], v[36:39], v[40:43], v[60:75]
  ds_read_b128 v[32:35], v218 offset:47104
  ds_read_b64_tr_b16 v[28:29], v221 offset:55296
  ds_read_b64_tr_b16 v[30:31], v221 offset:55808
  s_waitcnt lgkmcnt(9)
  v_mfma_f32_32x32x16_bf16 v[60:75], v[4:7], v[8:11], v[60:75]
  s_barrier
  ds_read_b128 v[40:43], v218 offset:57344
  ds_read_b64_tr_b16 v[36:37], v220 offset:8192
  ds_read_b64_tr_b16 v[38:39], v220 offset:8704
  s_waitcnt lgkmcnt(9)
  v_mfma_f32_32x32x16_bf16 v[60:75], v[12:15], v[16:19], v[60:75]
  ds_read_b128 v[8:11], v218 offset:59392
  ds_read_b64_tr_b16 v[4:5], v220 offset:10240
  ds_read_b64_tr_b16 v[6:7], v220 offset:10752
  s_waitcnt lgkmcnt(9)
  v_mfma_f32_32x32x16_bf16 v[60:75], v[20:23], v[24:27], v[60:75]
  ds_read_b128 v[16:19], v218 offset:61440
  ds_read_b64_tr_b16 v[12:13], v220 offset:12288
  ds_read_b64_tr_b16 v[14:15], v220 offset:12800
  s_waitcnt lgkmcnt(9)
  v_mfma_f32_32x32x16_bf16 v[60:75], v[28:31], v[32:35], v[60:75]
  ds_read_b128 v[24:27], v218 offset:63488
  ds_read_b64_tr_b16 v[20:21], v220 offset:14336
  ds_read_b64_tr_b16 v[22:23], v220 offset:14848
  s_waitcnt lgkmcnt(9)
  v_mfma_f32_32x32x16_bf16 v[60:75], v[36:39], v[40:43], v[60:75]
  ds_read_b128 v[32:35], v217 offset:0
  ds_read_b64_tr_b16 v[28:29], v220 offset:16384
  ds_read_b64_tr_b16 v[30:31], v220 offset:16896
  s_waitcnt lgkmcnt(9)
  v_mfma_f32_32x32x16_bf16 v[60:75], v[4:7], v[8:11], v[60:75]
  ds_read_b128 v[40:43], v217 offset:2048
  ds_read_b64_tr_b16 v[36:37], v220 offset:18432
  ds_read_b64_tr_b16 v[38:39], v220 offset:18944
  s_waitcnt lgkmcnt(9)
  v_mfma_f32_32x32x16_bf16 v[60:75], v[12:15], v[16:19], v[60:75]
  ds_read_b128 v[8:11], v217 offset:4096
  ds_read_b64_tr_b16 v[4:5], v220 offset:20480
  ds_read_b64_tr_b16 v[6:7], v220 offset:20992
  s_waitcnt lgkmcnt(9)
  v_mfma_f32_32x32x16_bf16 v[60:75], v[20:23], v[24:27], v[60:75]
  ds_read_b128 v[16:19], v217 offset:6144
  ds_read_b64_tr_b16 v[12:13], v220 offset:22528
  ds_read_b64_tr_b16 v[14:15], v220 offset:23040
  s_waitcnt lgkmcnt(9)
  v_mfma_f32_32x32x16_bf16 v[60:75], v[28:31], v[32:35], v[60:75]
  s_waitcnt lgkmcnt(6)
  v_mfma_f32_32x32x16_bf16 v[60:75], v[36:39], v[40:43], v[60:75]
  s_waitcnt lgkmcnt(3)
  v_mfma_f32_32x32x16_bf16 v[60:75], v[4:7], v[8:11], v[60:75]
  s_waitcnt lgkmcnt(0)
  v_mfma_f32_32x32x16_bf16 v[60:75], v[12:15], v[16:19], v[60:75]
  s_add_u32 s55, s64, 0x200000
  v_lshlrev_b32 v253, 3, v235
  v_mov_b32 v244, 0
  v_mov_b32 v245, 0
  s_lshl_b32 s3, s48, 13
  s_add_u32 s56, s3, 0x980000
  s_lshl_b32 s3, s49, 1
  s_add_u32 s3, s3, s60
  s_lshl_b32 s3, s3, 9
  s_add_u32 s57, s3, s56
s_nop 1
  v_cvt_pk_bf16_f32 v152, v60, v61
  v_cvt_pk_bf16_f32 v153, v62, v63
  v_cvt_pk_bf16_f32 v154, v64, v65
  v_cvt_pk_bf16_f32 v155, v66, v67
  v_cvt_pk_bf16_f32 v156, v68, v69
  v_cvt_pk_bf16_f32 v157, v70, v71
  v_cvt_pk_bf16_f32 v158, v72, v73
  v_cvt_pk_bf16_f32 v159, v74, v75
  buffer_store_dwordx4 v[152:155], v249, s[28:31], s55 offen offset:0 sc1
  buffer_store_dwordx4 v[156:159], v249, s[28:31], s55 offen offset:2048 sc1
  v_dot2c_f32_bf16 v244, v216, v152
  v_dot2c_f32_bf16 v245, v152, v152
  v_dot2c_f32_bf16 v244, v216, v153
  v_dot2c_f32_bf16 v245, v153, v153
  v_dot2c_f32_bf16 v244, v216, v154
  v_dot2c_f32_bf16 v245, v154, v154
  v_dot2c_f32_bf16 v244, v216, v155
  v_dot2c_f32_bf16 v245, v155, v155
  v_dot2c_f32_bf16 v244, v216, v156
  v_dot2c_f32_bf16 v245, v156, v156
  v_dot2c_f32_bf16 v244, v216, v157
  v_dot2c_f32_bf16 v245, v157, v157
  v_dot2c_f32_bf16 v244, v216, v158
  v_dot2c_f32_bf16 v245, v158, v158
  v_dot2c_f32_bf16 v244, v216, v159
  v_dot2c_f32_bf16 v245, v159, v159
s_nop 2
  v_permlane32_swap_b32 v244, v245
  v_add_f32 v244, v244, v245
  v_mov_b32 v245, v244
s_nop 1
  v_permlane32_swap_b32 v244, v245
  s_mov_b32 exec_hi, 0
  buffer_store_dwordx2 v[244:245], v253, s[28:31], s57 offen sc1
  s_mov_b64 exec, -1
  buffer_store_dwordx4 v[76:79], v246, s[28:31], s32 offen sc1
  buffer_store_dwordx4 v[80:83], v246, s[28:31], s33 offen sc1
  s_barrier
  s_lshl_b32 s3, s60, 12
  v_add_u32 v255, s3, v218
  ds_write_b128 v255, v[152:155] offset:57344
  ds_write_b128 v255, v[156:159] offset:59392
  v_lshl_add_u32 v251, v224, 7, v223
  s_mul_i32 s3, s60, 3
  s_add_u32 s3, s3, 0
  s_and_b32 s55, s3, 1
  s_lshr_b32 s3, s3, 1
  s_lshl_b32 s3, s3, 12
  v_xor_b32 v250, s55, v225
  v_lshl_add_u32 v250, v250, 6, v251
  v_add_u32 v246, s3, v250
  v_add_u32 v243, 0x10000, v246
  s_mul_i32 s3, s60, 3
  s_add_u32 s3, s3, 1
  s_and_b32 s55, s3, 1
  s_lshr_b32 s3, s3, 1
  s_lshl_b32 s3, s3, 12
  v_xor_b32 v250, s55, v225
  v_lshl_add_u32 v250, v250, 6, v251
  v_add_u32 v242, s3, v250
  v_add_u32 v241, 0x10000, v242
  s_mul_i32 s3, s60, 3
  s_add_u32 s3, s3, 2
  s_and_b32 s55, s3, 1
  s_lshr_b32 s3, s3, 1
  s_lshl_b32 s3, s3, 12
  v_xor_b32 v250, s55, v225
  v_lshl_add_u32 v250, v250, 6, v251
  v_add_u32 v240, s3, v250
  v_add_u32 v239, 0x10000, v240
  v_lshl_add_u32 v251, v234, 12, v253
  s_waitcnt lgkmcnt(0)
  s_waitcnt vmcnt(2)
  s_barrier
  v_mul_u32_u24 v238, 0xc00, v234
  v_lshl_add_u32 v238, v215, 1, v238
  s_lshr_b32 s3, s48, 4
  s_lshl_b32 s3, s3, 2
  s_add_u32 s3, s3, s100
  s_lshl_b32 s3, s3, 3
  s_add_u32 s3, s3, s49
  s_mul_i32 s3, s3, 0x1800
  s_mul_i32 s55, s60, 0x300
  s_add_u32 s3, s3, s55
  s_add_u32 s55, s3, 0xe30000
  s_lshl_b32 s3, s60, 2
  s_add_u32 s3, s3, s52
  s_lshl_b32 s3, s3, 10
  s_add_u32 s3, s3, 0x1e000
  v_lshrrev_b32 v255, 1, v247
  v_lshlrev_b32 v255, 9, v255
  v_lshl_add_u32 v255, v248, 4, v255
  v_and_b32 v254, 1, v247
  v_lshl_add_u32 v255, v254, 3, v255
  v_add_u32 v255, s3, v255
  ds_read_b64 v[152:153], v255 offset:0
  ds_read_b64 v[154:155], v255 offset:256
  ds_read_b64 v[156:157], v255 offset:2048
  ds_read_b64 v[158:159], v255 offset:2304
  v_add_u32 v251, 0x12000, v251
  s_mul_i32 s33, s49, 5
  s_min_u32 s3, s49, 3
  s_add_u32 s33, s33, s3
  s_mul_i32 s3, s60, 3
  s_add_u32 s33, s33, s3
  s_lshl_b32 s33, s33, 2
  s_add_u32 s33, s33, s52
  s_lshl_b32 s33, s33, 10
  s_add_u32 s33, s33, s62
  s_sub_u32 s3, s49, 3
  s_cmp_lt_u32 s3, 5
  s_cselect_b32 s57, s60, 0
  s_mov_b32 s56, s64
  ds_read_b128 v[80:83], v218 offset:57344
  ds_read_b64_tr_b16 v[68:69], v246 offset:0
  ds_read_b64_tr_b16 v[70:71], v246 offset:512
  ds_read_b64_tr_b16 v[72:73], v242 offset:0
  ds_read_b64_tr_b16 v[74:75], v242 offset:512
  ds_read_b64_tr_b16 v[76:77], v240 offset:0
  ds_read_b64_tr_b16 v[78:79], v240 offset:512
  ds_read_b128 v[96:99], v218 offset:59392
  ds_read_b64_tr_b16 v[84:85], v246 offset:2048
  ds_read_b64_tr_b16 v[86:87], v246 offset:2560
  ds_read_b64_tr_b16 v[88:89], v242 offset:2048
  ds_read_b64_tr_b16 v[90:91], v242 offset:2560
  ds_read_b64_tr_b16 v[92:93], v240 offset:2048
  ds_read_b64_tr_b16 v[94:95], v240 offset:2560
  s_waitcnt lgkmcnt(7)
  v_mfma_f32_32x32x16_bf16 v[20:35], v[68:71], v[80:83], 0
  ds_read_b128 v[112:115], v218 offset:61440
  ds_read_b64_tr_b16 v[100:101], v246 offset:12288
  ds_read_b64_tr_b16 v[102:103], v246 offset:12800
  v_mfma_f32_32x32x16_bf16 v[36:51], v[72:75], v[80:83], 0
  ds_read_b64_tr_b16 v[104:105], v242 offset:12288
  ds_read_b64_tr_b16 v[106:107], v242 offset:12800
  ds_read_b64_tr_b16 v[108:109], v240 offset:12288
  v_mfma_f32_32x32x16_bf16 v[52:67], v[76:79], v[80:83], 0
  ds_read_b64_tr_b16 v[110:111], v240 offset:12800
  s_waitcnt lgkmcnt(7)
  v_mfma_f32_32x32x16_bf16 v[20:35], v[84:87], v[96:99], v[20:35]
  ds_read_b128 v[80:83], v218 offset:63488
  ds_read_b64_tr_b16 v[68:69], v246 offset:14336
  ds_read_b64_tr_b16 v[70:71], v246 offset:14848
  v_mfma_f32_32x32x16_bf16 v[36:51], v[88:91], v[96:99], v[36:51]
  ds_read_b64_tr_b16 v[72:73], v242 offset:14336
  ds_read_b64_tr_b16 v[74:75], v242 offset:14848
  ds_read_b64_tr_b16 v[76:77], v240 offset:14336
  v_mfma_f32_32x32x16_bf16 v[52:67], v[92:95], v[96:99], v[52:67]
  ds_read_b64_tr_b16 v[78:79], v240 offset:14848
  s_waitcnt lgkmcnt(7)
  v_mfma_f32_32x32x16_bf16 v[20:35], v[100:103], v[112:115], v[20:35]
  v_mfma_f32_32x32x16_bf16 v[36:51], v[104:107], v[112:115], v[36:51]
  v_mfma_f32_32x32x16_bf16 v[52:67], v[108:111], v[112:115], v[52:67]
  s_waitcnt lgkmcnt(0)
  v_mfma_f32_32x32x16_bf16 v[20:35], v[68:71], v[80:83], v[20:35]
  v_mfma_f32_32x32x16_bf16 v[36:51], v[72:75], v[80:83], v[36:51]
  v_mfma_f32_32x32x16_bf16 v[52:67], v[76:79], v[80:83], v[52:67]
  s_cmp_lg_u32 s51, 0
  s_cbranch_scc1 Lnopoll_42
  s_lshl_b32 s63, s48, 12
  s_add_u32 s63, s63, 0xe00400
  s_add_u32 s44, s28, s63
  s_addc_u32 s45, s29, 0
  s_add_u32 s34, s65, 2
  s_mov_b32 s35, s34
  s_waitcnt lgkmcnt(0)
  s_mov_b32 s59, 0
Lspoll_44:
  s_load_dwordx8 s[36:43], s[44:45], s59
  s_add_u32 s59, s59, 64
  s_waitcnt lgkmcnt(0)
  s_xor_b64 s[46:47], s[36:37], s[34:35]
  s_xor_b64 s[0:1], s[38:39], s[34:35]
  s_or_b64 s[46:47], s[46:47], s[0:1]
  s_xor_b64 s[0:1], s[40:41], s[34:35]
  s_or_b64 s[46:47], s[46:47], s[0:1]
  s_xor_b64 s[0:1], s[42:43], s[34:35]
  s_or_b64 s[46:47], s[46:47], s[0:1]
  s_cbranch_scc0 Lpollok_43
  s_cmp_lt_u32 s59, 1024
  s_cbranch_scc1 Lspoll_44
  v_and_b32 v250, 28, v215
  s_mov_b32 s59, 0
Lpoll_45:
  buffer_load_dword v255, v250, s[28:31], s63 offen sc1
  s_waitcnt vmcnt(0)
  v_cmp_eq_u32 vcc, s34, v255
  s_add_u32 s59, s59, 1
  s_cmp_eq_u64 vcc, exec
  s_cbranch_scc1 Lpollok_46
  s_cmp_lt_u32 s59, 0x40000
  s_cbranch_scc1 Lpoll_45
Lpollok_46:
Lpollok_43:
Lnopoll_42:
  s_waitcnt vmcnt(0)
  s_barrier
  s_barrier
  ds_read_b128 v[96:99], v217 offset:0
  ds_read_b64_tr_b16 v[84:85], v246 offset:24576
  ds_read_b64_tr_b16 v[86:87], v246 offset:25088
  ds_read_b64_tr_b16 v[88:89], v242 offset:24576
  ds_read_b64_tr_b16 v[90:91], v242 offset:25088
  ds_read_b64_tr_b16 v[92:93], v240 offset:24576
  ds_read_b64_tr_b16 v[94:95], v240 offset:25088
  ds_read_b128 v[112:115], v217 offset:2048
  ds_read_b64_tr_b16 v[100:101], v246 offset:26624
  ds_read_b64_tr_b16 v[102:103], v246 offset:27136
  ds_read_b64_tr_b16 v[104:105], v242 offset:26624
  ds_read_b64_tr_b16 v[106:107], v242 offset:27136
  ds_read_b64_tr_b16 v[108:109], v240 offset:26624
  ds_read_b64_tr_b16 v[110:111], v240 offset:27136
  s_waitcnt lgkmcnt(7)
  v_mfma_f32_32x32x16_bf16 v[20:35], v[84:87], v[96:99], v[20:35]
  ds_read_b128 v[80:83], v217 offset:4096
  ds_read_b64_tr_b16 v[68:69], v246 offset:36864
  ds_read_b64_tr_b16 v[70:71], v246 offset:37376
  v_mfma_f32_32x32x16_bf16 v[36:51], v[88:91], v[96:99], v[36:51]
  ds_read_b64_tr_b16 v[72:73], v242 offset:36864
  ds_read_b64_tr_b16 v[74:75], v242 offset:37376
  v_mfma_f32_32x32x16_bf16 v[52:67], v[92:95], v[96:99], v[52:67]
  ds_read_b64_tr_b16 v[76:77], v240 offset:36864
  ds_read_b64_tr_b16 v[78:79], v240 offset:37376
  s_waitcnt lgkmcnt(7)
  v_mfma_f32_32x32x16_bf16 v[20:35], v[100:103], v[112:115], v[20:35]
  ds_read_b128 v[96:99], v217 offset:6144
  ds_read_b64_tr_b16 v[84:85], v246 offset:38912
  ds_read_b64_tr_b16 v[86:87], v246 offset:39424
  v_mfma_f32_32x32x16_bf16 v[36:51], v[104:107], v[112:115], v[36:51]
  ds_read_b64_tr_b16 v[88:89], v242 offset:38912
  ds_read_b64_tr_b16 v[90:91], v242 offset:39424
  v_mfma_f32_32x32x16_bf16 v[52:67], v[108:111], v[112:115], v[52:67]
  ds_read_b64_tr_b16 v[92:93], v240 offset:38912
  ds_read_b64_tr_b16 v[94:95], v240 offset:39424
  s_waitcnt lgkmcnt(7)
  v_mfma_f32_32x32x16_bf16 v[20:35], v[68:71], v[80:83], v[20:35]
  s_waitcnt lgkmcnt(0)
  s_barrier
  ds_read_b128 v[112:115], v217 offset:8192
  ds_read_b64_tr_b16 v[100:101], v246 offset:49152
  ds_read_b64_tr_b16 v[102:103], v246 offset:49664
  v_mfma_f32_32x32x16_bf16 v[36:51], v[72:75], v[80:83], v[36:51]
  ds_read_b64_tr_b16 v[104:105], v242 offset:49152
  ds_read_b64_tr_b16 v[106:107], v242 offset:49664
  v_mfma_f32_32x32x16_bf16 v[52:67], v[76:79], v[80:83], v[52:67]
  ds_read_b64_tr_b16 v[108:109], v240 offset:49152
  ds_read_b64_tr_b16 v[110:111], v240 offset:49664
  v_mfma_f32_32x32x16_bf16 v[20:35], v[84:87], v[96:99], v[20:35]
  ds_read_b128 v[80:83], v217 offset:10240
  ds_read_b64_tr_b16 v[68:69], v246 offset:51200
  ds_read_b64_tr_b16 v[70:71], v246 offset:51712
  v_mfma_f32_32x32x16_bf16 v[36:51], v[88:91], v[96:99], v[36:51]
  ds_read_b64_tr_b16 v[72:73], v242 offset:51200
  ds_read_b64_tr_b16 v[74:75], v242 offset:51712
  v_mfma_f32_32x32x16_bf16 v[52:67], v[92:95], v[96:99], v[52:67]
  ds_read_b64_tr_b16 v[76:77], v240 offset:51200
  ds_read_b64_tr_b16 v[78:79], v240 offset:51712
  s_waitcnt lgkmcnt(7)
  v_mfma_f32_32x32x16_bf16 v[20:35], v[100:103], v[112:115], v[20:35]
  ds_read_b128 v[96:99], v217 offset:12288
  ds_read_b64_tr_b16 v[84:85], v246 offset:61440
  ds_read_b64_tr_b16 v[86:87], v246 offset:61952
  v_mfma_f32_32x32x16_bf16 v[36:51], v[104:107], v[112:115], v[36:51]
  ds_read_b64_tr_b16 v[88:89], v242 offset:61440
  ds_read_b64_tr_b16 v[90:91], v242 offset:61952
  v_mfma_f32_32x32x16_bf16 v[52:67], v[108:111], v[112:115], v[52:67]
  ds_read_b64_tr_b16 v[92:93], v240 offset:61440
  ds_read_b64_tr_b16 v[94:95], v240 offset:61952
  s_waitcnt lgkmcnt(7)
  v_mfma_f32_32x32x16_bf16 v[20:35], v[68:71], v[80:83], v[20:35]
  ds_read_b128 v[112:115], v217 offset:14336
  ds_read_b64_tr_b16 v[100:101], v246 offset:63488
  ds_read_b64_tr_b16 v[102:103], v246 offset:64000
  v_mfma_f32_32x32x16_bf16 v[36:51], v[72:75], v[80:83], v[36:51]
  ds_read_b64_tr_b16 v[104:105], v242 offset:63488
  ds_read_b64_tr_b16 v[106:107], v242 offset:64000
  v_mfma_f32_32x32x16_bf16 v[52:67], v[76:79], v[80:83], v[52:67]
  ds_read_b64_tr_b16 v[108:109], v240 offset:63488
  ds_read_b64_tr_b16 v[110:111], v240 offset:64000
  s_waitcnt lgkmcnt(7)
  v_mfma_f32_32x32x16_bf16 v[20:35], v[84:87], v[96:99], v[20:35]
  s_waitcnt lgkmcnt(0)
  s_barrier
  ds_read_b128 v[80:83], v217 offset:16384
  ds_read_b64_tr_b16 v[68:69], v243 offset:8192
  ds_read_b64_tr_b16 v[70:71], v243 offset:8704
  v_mfma_f32_32x32x16_bf16 v[36:51], v[88:91], v[96:99], v[36:51]
  ds_read_b64_tr_b16 v[72:73], v241 offset:8192
  ds_read_b64_tr_b16 v[74:75], v241 offset:8704
  v_mfma_f32_32x32x16_bf16 v[52:67], v[92:95], v[96:99], v[52:67]
  ds_read_b64_tr_b16 v[76:77], v239 offset:8192
  ds_read_b64_tr_b16 v[78:79], v239 offset:8704
  v_mfma_f32_32x32x16_bf16 v[20:35], v[100:103], v[112:115], v[20:35]
  ds_read_b128 v[96:99], v217 offset:18432
  ds_read_b64_tr_b16 v[84:85], v243 offset:10240
  ds_read_b64_tr_b16 v[86:87], v243 offset:10752
  v_mfma_f32_32x32x16_bf16 v[36:51], v[104:107], v[112:115], v[36:51]
  ds_read_b64_tr_b16 v[88:89], v241 offset:10240
  ds_read_b64_tr_b16 v[90:91], v241 offset:10752
  v_mfma_f32_32x32x16_bf16 v[52:67], v[108:111], v[112:115], v[52:67]
  ds_read_b64_tr_b16 v[92:93], v239 offset:10240
  ds_read_b64_tr_b16 v[94:95], v239 offset:10752
  s_waitcnt lgkmcnt(7)
  v_mfma_f32_32x32x16_bf16 v[20:35], v[68:71], v[80:83], v[20:35]
  ds_read_b128 v[112:115], v217 offset:20480
  ds_read_b64_tr_b16 v[100:101], v243 offset:20480
  ds_read_b64_tr_b16 v[102:103], v243 offset:20992
  v_mfma_f32_32x32x16_bf16 v[36:51], v[72:75], v[80:83], v[36:51]
  ds_read_b64_tr_b16 v[104:105], v241 offset:20480
  ds_read_b64_tr_b16 v[106:107], v241 offset:20992
  v_mfma_f32_32x32x16_bf16 v[52:67], v[76:79], v[80:83], v[52:67]
  ds_read_b64_tr_b16 v[108:109], v239 offset:20480
  ds_read_b64_tr_b16 v[110:111], v239 offset:20992
  s_waitcnt lgkmcnt(7)
  v_mfma_f32_32x32x16_bf16 v[20:35], v[84:87], v[96:99], v[20:35]
  ds_read_b128 v[80:83], v217 offset:22528
  ds_read_b64_tr_b16 v[68:69], v243 offset:22528
  ds_read_b64_tr_b16 v[70:71], v243 offset:23040
  v_mfma_f32_32x32x16_bf16 v[36:51], v[88:91], v[96:99], v[36:51]
  ds_read_b64_tr_b16 v[72:73], v241 offset:22528
  ds_read_b64_tr_b16 v[74:75], v241 offset:23040
  v_mfma_f32_32x32x16_bf16 v[52:67], v[92:95], v[96:99], v[52:67]
  ds_read_b64_tr_b16 v[76:77], v239 offset:22528
  ds_read_b64_tr_b16 v[78:79], v239 offset:23040
  s_waitcnt lgkmcnt(7)
  v_mfma_f32_32x32x16_bf16 v[20:35], v[100:103], v[112:115], v[20:35]
  s_waitcnt lgkmcnt(0)
  s_barrier
  ds_read_b128 v[96:99], v218 offset:57344
  ds_read_b64_tr_b16 v[84:85], v243 offset:32768
  ds_read_b64_tr_b16 v[86:87], v243 offset:33280
  v_mfma_f32_32x32x16_bf16 v[36:51], v[104:107], v[112:115], v[36:51]
  ds_read_b64_tr_b16 v[88:89], v241 offset:32768
  ds_read_b64_tr_b16 v[90:91], v241 offset:33280
  v_mfma_f32_32x32x16_bf16 v[52:67], v[108:111], v[112:115], v[52:67]
  ds_read_b64_tr_b16 v[92:93], v239 offset:32768
  ds_read_b64_tr_b16 v[94:95], v239 offset:33280
  v_mfma_f32_32x32x16_bf16 v[20:35], v[68:71], v[80:83], v[20:35]
  ds_read_b128 v[112:115], v218 offset:59392
  ds_read_b64_tr_b16 v[100:101], v243 offset:34816
  ds_read_b64_tr_b16 v[102:103], v243 offset:35328
  v_mfma_f32_32x32x16_bf16 v[36:51], v[72:75], v[80:83], v[36:51]
  ds_read_b64_tr_b16 v[104:105], v241 offset:34816
  ds_read_b64_tr_b16 v[106:107], v241 offset:35328
  v_mfma_f32_32x32x16_bf16 v[52:67], v[76:79], v[80:83], v[52:67]
  ds_read_b64_tr_b16 v[108:109], v239 offset:34816
  ds_read_b64_tr_b16 v[110:111], v239 offset:35328
  s_waitcnt lgkmcnt(7)
  v_mfma_f32_32x32x16_bf16 v[20:35], v[84:87], v[96:99], v[20:35]
  ds_read_b128 v[80:83], v218 offset:61440
  ds_read_b64_tr_b16 v[68:69], v243 offset:45056
  ds_read_b64_tr_b16 v[70:71], v243 offset:45568
  v_mfma_f32_32x32x16_bf16 v[36:51], v[88:91], v[96:99], v[36:51]
  ds_read_b64_tr_b16 v[72:73], v241 offset:45056
  ds_read_b64_tr_b16 v[74:75], v241 offset:45568
  v_mfma_f32_32x32x16_bf16 v[52:67], v[92:95], v[96:99], v[52:67]
  ds_read_b64_tr_b16 v[76:77], v239 offset:45056
  ds_read_b64_tr_b16 v[78:79], v239 offset:45568
  s_waitcnt lgkmcnt(7)
  v_mfma_f32_32x32x16_bf16 v[20:35], v[100:103], v[112:115], v[20:35]
  ds_read_b128 v[96:99], v218 offset:63488
  ds_read_b64_tr_b16 v[84:85], v243 offset:47104
  ds_read_b64_tr_b16 v[86:87], v243 offset:47616
  v_mfma_f32_32x32x16_bf16 v[36:51], v[104:107], v[112:115], v[36:51]
  ds_read_b64_tr_b16 v[88:89], v241 offset:47104
  ds_read_b64_tr_b16 v[90:91], v241 offset:47616
  v_mfma_f32_32x32x16_bf16 v[52:67], v[108:111], v[112:115], v[52:67]
  ds_read_b64_tr_b16 v[92:93], v239 offset:47104
  ds_read_b64_tr_b16 v[94:95], v239 offset:47616
  s_waitcnt lgkmcnt(7)
  v_mfma_f32_32x32x16_bf16 v[20:35], v[68:71], v[80:83], v[20:35]
  s_waitcnt lgkmcnt(0)
  s_barrier
  ds_read_b128 v[112:115], v217 offset:0
  ds_read_b64_tr_b16 v[100:101], v246 offset:0
  ds_read_b64_tr_b16 v[102:103], v246 offset:512
  v_mfma_f32_32x32x16_bf16 v[36:51], v[72:75], v[80:83], v[36:51]
  ds_read_b64_tr_b16 v[104:105], v242 offset:0
  ds_read_b64_tr_b16 v[106:107], v242 offset:512
  v_mfma_f32_32x32x16_bf16 v[52:67], v[76:79], v[80:83], v[52:67]
  ds_read_b64_tr_b16 v[108:109], v240 offset:0
  ds_read_b64_tr_b16 v[110:111], v240 offset:512
  v_mfma_f32_32x32x16_bf16 v[20:35], v[84:87], v[96:99], v[20:35]
  ds_read_b128 v[80:83], v217 offset:2048
  ds_read_b64_tr_b16 v[68:69], v246 offset:2048
  ds_read_b64_tr_b16 v[70:71], v246 offset:2560
  v_mfma_f32_32x32x16_bf16 v[36:51], v[88:91], v[96:99], v[36:51]
  ds_read_b64_tr_b16 v[72:73], v242 offset:2048
  ds_read_b64_tr_b16 v[74:75], v242 offset:2560
  v_mfma_f32_32x32x16_bf16 v[52:67], v[92:95], v[96:99], v[52:67]
  ds_read_b64_tr_b16 v[76:77], v240 offset:2048
  ds_read_b64_tr_b16 v[78:79], v240 offset:2560
  s_waitcnt lgkmcnt(7)
  v_mfma_f32_32x32x16_bf16 v[20:35], v[100:103], v[112:115], v[20:35]
  ds_read_b128 v[96:99], v217 offset:4096
  ds_read_b64_tr_b16 v[84:85], v246 offset:12288
  ds_read_b64_tr_b16 v[86:87], v246 offset:12800
  v_mfma_f32_32x32x16_bf16 v[36:51], v[104:107], v[112:115], v[36:51]
  ds_read_b64_tr_b16 v[88:89], v242 offset:12288
  ds_read_b64_tr_b16 v[90:91], v242 offset:12800
  v_mfma_f32_32x32x16_bf16 v[52:67], v[108:111], v[112:115], v[52:67]
  ds_read_b64_tr_b16 v[92:93], v240 offset:12288
  ds_read_b64_tr_b16 v[94:95], v240 offset:12800
  s_waitcnt lgkmcnt(7)
  v_mfma_f32_32x32x16_bf16 v[20:35], v[68:71], v[80:83], v[20:35]
  ds_read_b128 v[112:115], v217 offset:6144
  ds_read_b64_tr_b16 v[100:101], v246 offset:14336
  ds_read_b64_tr_b16 v[102:103], v246 offset:14848
  v_mfma_f32_32x32x16_bf16 v[36:51], v[72:75], v[80:83], v[36:51]
  ds_read_b64_tr_b16 v[104:105], v242 offset:14336
  ds_read_b64_tr_b16 v[106:107], v242 offset:14848
  v_mfma_f32_32x32x16_bf16 v[52:67], v[76:79], v[80:83], v[52:67]
  ds_read_b64_tr_b16 v[108:109], v240 offset:14336
  ds_read_b64_tr_b16 v[110:111], v240 offset:14848
  s_mul_i32 s3, s60, 0x300
  s_add_u32 s3, s3, 0x26000
  v_add_u32 v254, s3, v238
  s_waitcnt lgkmcnt(7)
  v_mfma_f32_32x32x16_bf16 v[20:35], v[84:87], v[96:99], v[20:35]
  s_waitcnt lgkmcnt(0)
  s_barrier
  ds_read_b128 v[80:83], v217 offset:8192
  ds_read_b64_tr_b16 v[68:69], v246 offset:24576
  ds_read_b64_tr_b16 v[70:71], v246 offset:25088
  v_mfma_f32_32x32x16_bf16 v[36:51], v[88:91], v[96:99], v[36:51]
  ds_read_b64_tr_b16 v[72:73], v242 offset:24576
  ds_read_b64_tr_b16 v[74:75], v242 offset:25088
  v_mfma_f32_32x32x16_bf16 v[52:67], v[92:95], v[96:99], v[52:67]
  ds_read_b64_tr_b16 v[76:77], v240 offset:24576
  ds_read_b64_tr_b16 v[78:79], v240 offset:25088
  ds_read_b64 v[4:5], v251 offset:0
  ds_read_b64 v[6:7], v251 offset:512
  ds_read_b64 v[8:9], v251 offset:1024
  ds_read_b64 v[10:11], v251 offset:1536
  v_mfma_f32_32x32x16_bf16 v[20:35], v[100:103], v[112:115], v[20:35]
  ds_read_b128 v[96:99], v217 offset:10240
  ds_read_b64_tr_b16 v[84:85], v246 offset:26624
  ds_read_b64_tr_b16 v[86:87], v246 offset:27136
  v_mfma_f32_32x32x16_bf16 v[36:51], v[104:107], v[112:115], v[36:51]
  ds_read_b64_tr_b16 v[88:89], v242 offset:26624
  ds_read_b64_tr_b16 v[90:91], v242 offset:27136
  v_mfma_f32_32x32x16_bf16 v[52:67], v[108:111], v[112:115], v[52:67]
  ds_read_b64_tr_b16 v[92:93], v240 offset:26624
  ds_read_b64_tr_b16 v[94:95], v240 offset:27136
  ds_read_b64 v[12:13], v251 offset:2048
  ds_read_b64 v[14:15], v251 offset:2560
  ds_read_b64 v[16:17], v251 offset:3072
  ds_read_b64 v[18:19], v251 offset:3584
  s_waitcnt lgkmcnt(11)
  v_mfma_f32_32x32x16_bf16 v[20:35], v[68:71], v[80:83], v[20:35]
  ds_read_b128 v[112:115], v217 offset:12288
  ds_read_b64_tr_b16 v[100:101], v246 offset:36864
  ds_read_b64_tr_b16 v[102:103], v246 offset:37376
  v_mfma_f32_32x32x16_bf16 v[36:51], v[72:75], v[80:83], v[36:51]
  ds_read_b64_tr_b16 v[104:105], v242 offset:36864
  ds_read_b64_tr_b16 v[106:107], v242 offset:37376
  v_mfma_f32_32x32x16_bf16 v[52:67], v[76:79], v[80:83], v[52:67]
  ds_read_b64_tr_b16 v[108:109], v240 offset:36864
  ds_read_b64_tr_b16 v[110:111], v240 offset:37376
  s_waitcnt lgkmcnt(7)
  v_mfma_f32_32x32x16_bf16 v[20:35], v[84:87], v[96:99], v[20:35]
  ds_read_b128 v[80:83], v217 offset:14336
  ds_read_b64_tr_b16 v[68:69], v246 offset:38912
  ds_read_b64_tr_b16 v[70:71], v246 offset:39424
  v_mfma_f32_32x32x16_bf16 v[36:51], v[88:91], v[96:99], v[36:51]
  ds_read_b64_tr_b16 v[72:73], v242 offset:38912
  ds_read_b64_tr_b16 v[74:75], v242 offset:39424
  v_mfma_f32_32x32x16_bf16 v[52:67], v[92:95], v[96:99], v[52:67]
  ds_read_b64_tr_b16 v[76:77], v240 offset:38912
  ds_read_b64_tr_b16 v[78:79], v240 offset:39424
  v_add_f32 v4, v4, v12
  v_add_f32 v5, v5, v13
  v_add_f32 v6, v6, v14
  v_add_f32 v7, v7, v15
  v_add_f32 v8, v8, v16
  v_add_f32 v9, v9, v17
  v_add_f32 v10, v10, v18
  v_add_f32 v11, v11, v19
  v_add_f32 v4, v4, v8
  v_add_f32 v5, v5, v9
  v_add_f32 v6, v6, v10
  v_add_f32 v7, v7, v11
  s_waitcnt lgkmcnt(7)
  v_mfma_f32_32x32x16_bf16 v[20:35], v[100:103], v[112:115], v[20:35]
  s_waitcnt lgkmcnt(0)
  s_barrier
  ds_read_b128 v[96:99], v217 offset:16384
  ds_read_b64_tr_b16 v[84:85], v246 offset:49152
  ds_read_b64_tr_b16 v[86:87], v246 offset:49664
  v_mfma_f32_32x32x16_bf16 v[36:51], v[104:107], v[112:115], v[36:51]
  ds_read_b64_tr_b16 v[88:89], v242 offset:49152
  ds_read_b64_tr_b16 v[90:91], v242 offset:49664
  v_mfma_f32_32x32x16_bf16 v[52:67], v[108:111], v[112:115], v[52:67]
  ds_read_b64_tr_b16 v[92:93], v240 offset:49152
  ds_read_b64_tr_b16 v[94:95], v240 offset:49664
  v_add_f32 v4, v4, v6
  v_add_f32 v5, v5, v7
s_nop 1
  v_permlane32_swap_b32 v4, v5
  v_add_f32 v4, v4, v5
  v_mov_b32 v5, v4
s_nop 1
  v_permlane32_swap_b32 v4, v5
  v_mfma_f32_32x32x16_bf16 v[20:35], v[68:71], v[80:83], v[20:35]
  ds_read_b128 v[112:115], v217 offset:18432
  ds_read_b64_tr_b16 v[100:101], v246 offset:51200
  ds_read_b64_tr_b16 v[102:103], v246 offset:51712
  v_mfma_f32_32x32x16_bf16 v[36:51], v[72:75], v[80:83], v[36:51]
  ds_read_b64_tr_b16 v[104:105], v242 offset:51200
  ds_read_b64_tr_b16 v[106:107], v242 offset:51712
  v_mfma_f32_32x32x16_bf16 v[52:67], v[76:79], v[80:83], v[52:67]
  ds_read_b64_tr_b16 v[108:109], v240 offset:51200
  ds_read_b64_tr_b16 v[110:111], v240 offset:51712
  v_mul_f32 v213, 0x3b000000, v4
  v_mul_f32 v255, v213, v213
  v_fmamk_f32 v5, v5, 0xbb000000, v255
  v_max_f32 v5, -v5, 0
  v_add_f32 v255, 0x3727c5ac, v5
  v_rsq_f32 v212, v255
  s_waitcnt lgkmcnt(7)
  v_mfma_f32_32x32x16_bf16 v[20:35], v[84:87], v[96:99], v[20:35]
  ds_read_b128 v[80:83], v217 offset:20480
  ds_read_b64_tr_b16 v[68:69], v246 offset:61440
  ds_read_b64_tr_b16 v[70:71], v246 offset:61952
  v_mfma_f32_32x32x16_bf16 v[36:51], v[88:91], v[96:99], v[36:51]
  ds_read_b64_tr_b16 v[72:73], v242 offset:61440
  ds_read_b64_tr_b16 v[74:75], v242 offset:61952
  v_mfma_f32_32x32x16_bf16 v[52:67], v[92:95], v[96:99], v[52:67]
  ds_read_b64_tr_b16 v[76:77], v240 offset:61440
  ds_read_b64_tr_b16 v[78:79], v240 offset:61952
  v_cvt_pk_bf16_f32 v176, -v213, -v213
  v_and_b32 v255, 0xffff0000, v176
  v_sub_f32 v255, -v213, v255
  v_cvt_pk_bf16_f32 v177, v255, v255
  v_mov_b32 v178, v176
  v_mov_b32 v179, v177
  v_mul_f32 v255, v212, v212
  v_mul_f32 v207, 0xc0135761, v212
  v_mul_f32 v255, 0x3d372713, v255
  v_mul_f32 v206, v255, v207
  v_rcp_f32 v204, v212
  s_waitcnt lgkmcnt(7)
  v_mfma_f32_32x32x16_bf16 v[20:35], v[100:103], v[112:115], v[20:35]
  ds_read_b128 v[96:99], v217 offset:22528
  ds_read_b64_tr_b16 v[84:85], v246 offset:63488
  ds_read_b64_tr_b16 v[86:87], v246 offset:64000
  v_mfma_f32_32x32x16_bf16 v[36:51], v[104:107], v[112:115], v[36:51]
  ds_read_b64_tr_b16 v[88:89], v242 offset:63488
  ds_read_b64_tr_b16 v[90:91], v242 offset:64000
  v_mfma_f32_32x32x16_bf16 v[52:67], v[108:111], v[112:115], v[52:67]
  ds_read_b64_tr_b16 v[92:93], v240 offset:63488
  ds_read_b64_tr_b16 v[94:95], v240 offset:64000
  s_waitcnt lgkmcnt(7)
  v_mfma_f32_32x32x16_bf16 v[20:35], v[68:71], v[80:83], v[20:35]
  v_mfma_f32_32x32x16_bf16 v[36:51], v[72:75], v[80:83], v[36:51]
  v_mfma_f32_32x32x16_bf16 v[52:67], v[76:79], v[80:83], v[52:67]
  s_waitcnt lgkmcnt(0)
  s_barrier
  ds_read_b64 v[116:117], v254 offset:0
  ds_read_b64 v[118:119], v254 offset:1536
  ds_read_b64 v[120:121], v254 offset:256
  ds_read_b64 v[122:123], v254 offset:1792
  ds_read_b64 v[124:125], v254 offset:512
  ds_read_b64 v[126:127], v254 offset:2048
  v_mfma_f32_32x32x16_bf16 v[20:35], v[84:87], v[96:99], v[20:35]
  v_mfma_f32_32x32x16_bf16 v[36:51], v[88:91], v[96:99], v[36:51]
  v_mfma_f32_32x32x16_bf16 v[52:67], v[92:95], v[96:99], v[52:67]
  s_waitcnt lgkmcnt(0)
  v_xor_b32 v117, s65, v117
  v_xor_b32 v119, s65, v119
  v_xor_b32 v121, s65, v121
  v_xor_b32 v123, s65, v123
  v_xor_b32 v125, s65, v125
  v_xor_b32 v127, s65, v127
  v_or3_b32 v117, v117, v119, v121
  v_or3_b32 v123, v123, v125, v127
  v_or_b32 v117, v117, v123
  v_cmp_eq_u32 vcc, 0, v117
s_nop 0
  s_cmp_eq_u64 vcc, exec
  s_cbranch_scc1 Lok_47
  s_mov_b32 s59, 0
Lpoll_48:
  buffer_load_dwordx2 v[116:117], v238, s[28:31], s55 offen offset:0 sc1
  buffer_load_dwordx2 v[118:119], v238, s[28:31], s55 offen offset:1536 sc1
  buffer_load_dwordx2 v[120:121], v238, s[28:31], s55 offen offset:256 sc1
  buffer_load_dwordx2 v[122:123], v238, s[28:31], s55 offen offset:1792 sc1
  buffer_load_dwordx2 v[124:125], v238, s[28:31], s55 offen offset:512 sc1
  buffer_load_dwordx2 v[126:127], v238, s[28:31], s55 offen offset:2048 sc1
  s_waitcnt vmcnt(0)
  v_xor_b32 v117, s65, v117
  v_xor_b32 v119, s65, v119
  v_xor_b32 v121, s65, v121
  v_xor_b32 v123, s65, v123
  v_xor_b32 v125, s65, v125
  v_xor_b32 v127, s65, v127
  v_or3_b32 v117, v117, v119, v121
  v_or3_b32 v123, v123, v125, v127
  v_or_b32 v117, v117, v123
  v_cmp_eq_u32 vcc, 0, v117
  s_add_u32 s59, s59, 1
  s_cmp_eq_u64 vcc, exec
  s_cbranch_scc1 Lpollok_49
  s_cmp_lt_u32 s59, 0x40000
  s_cbranch_scc1 Lpoll_48
Lpollok_49:
Lok_47:
  v_mov_b32 v117, v116
  v_mov_b32 v119, v118
  v_mov_b32 v121, v120
  v_mov_b32 v123, v122
  v_mov_b32 v125, v124
  v_mov_b32 v127, v126
  s_mov_b32 s55, s33
  v_mfma_f32_32x32x16_bf16 v[20:35], v[116:119], v[176:179], v[20:35]
  v_mfma_f32_32x32x16_bf16 v[36:51], v[120:123], v[176:179], v[36:51]
  v_mfma_f32_32x32x16_bf16 v[52:67], v[124:127], v[176:179], v[52:67]
s_nop 9
  v_pk_mul_f32 v[68:69], v[20:21], v[20:21]
  v_pk_mul_f32 v[70:71], v[22:23], v[22:23]
  v_pk_mul_f32 v[72:73], v[24:25], v[24:25]
  v_pk_mul_f32 v[74:75], v[26:27], v[26:27]
  v_pk_fma_f32 v[68:69], v[68:69], v[206:207], v[206:207] op_sel:[0,0,1] op_sel_hi:[1,0,1]
  v_pk_fma_f32 v[70:71], v[70:71], v[206:207], v[206:207] op_sel:[0,0,1] op_sel_hi:[1,0,1]
  v_pk_fma_f32 v[72:73], v[72:73], v[206:207], v[206:207] op_sel:[0,0,1] op_sel_hi:[1,0,1]
  v_pk_fma_f32 v[74:75], v[74:75], v[206:207], v[206:207] op_sel:[0,0,1] op_sel_hi:[1,0,1]
  v_pk_mul_f32 v[68:69], v[68:69], v[20:21]
  v_pk_mul_f32 v[70:71], v[70:71], v[22:23]
  v_pk_mul_f32 v[72:73], v[72:73], v[24:25]
  v_pk_mul_f32 v[74:75], v[74:75], v[26:27]
  v_exp_f32 v68, v68
  v_exp_f32 v69, v69
  v_exp_f32 v70, v70
  v_exp_f32 v71, v71
  v_exp_f32 v72, v72
  v_exp_f32 v73, v73
  v_exp_f32 v74, v74
  v_exp_f32 v75, v75
  v_pk_fma_f32 v[68:69], v[68:69], v[204:205], v[204:205] op_sel_hi:[1,0,0]
  v_pk_fma_f32 v[70:71], v[70:71], v[204:205], v[204:205] op_sel_hi:[1,0,0]
  v_pk_fma_f32 v[72:73], v[72:73], v[204:205], v[204:205] op_sel_hi:[1,0,0]
  v_pk_fma_f32 v[74:75], v[74:75], v[204:205], v[204:205] op_sel_hi:[1,0,0]
  v_rcp_f32 v68, v68
  v_rcp_f32 v69, v69
  v_rcp_f32 v70, v70
  v_rcp_f32 v71, v71
  v_rcp_f32 v72, v72
  v_rcp_f32 v73, v73
  v_rcp_f32 v74, v74
  v_rcp_f32 v75, v75
  v_pk_mul_f32 v[68:69], v[68:69], v[20:21]
  v_pk_mul_f32 v[70:71], v[70:71], v[22:23]
  v_pk_mul_f32 v[72:73], v[72:73], v[24:25]
  v_pk_mul_f32 v[74:75], v[74:75], v[26:27]
  v_cvt_pk_bf16_f32 v12, v68, v69
  v_cvt_pk_bf16_f32 v13, v70, v71
  v_cvt_pk_bf16_f32 v14, v72, v73
  v_cvt_pk_bf16_f32 v15, v74, v75
  v_pk_mul_f32 v[68:69], v[28:29], v[28:29]
  v_pk_mul_f32 v[70:71], v[30:31], v[30:31]
  v_pk_mul_f32 v[72:73], v[32:33], v[32:33]
  v_pk_mul_f32 v[74:75], v[34:35], v[34:35]
  v_pk_fma_f32 v[68:69], v[68:69], v[206:207], v[206:207] op_sel:[0,0,1] op_sel_hi:[1,0,1]
  v_pk_fma_f32 v[70:71], v[70:71], v[206:207], v[206:207] op_sel:[0,0,1] op_sel_hi:[1,0,1]
  v_pk_fma_f32 v[72:73], v[72:73], v[206:207], v[206:207] op_sel:[0,0,1] op_sel_hi:[1,0,1]
  v_pk_fma_f32 v[74:75], v[74:75], v[206:207], v[206:207] op_sel:[0,0,1] op_sel_hi:[1,0,1]
  v_pk_mul_f32 v[68:69], v[68:69], v[28:29]
  v_pk_mul_f32 v[70:71], v[70:71], v[30:31]
  v_pk_mul_f32 v[72:73], v[72:73], v[32:33]
  v_pk_mul_f32 v[74:75], v[74:75], v[34:35]
  v_exp_f32 v68, v68
  v_exp_f32 v69, v69
  v_exp_f32 v70, v70
  v_exp_f32 v71, v71
  v_exp_f32 v72, v72
  v_exp_f32 v73, v73
  v_exp_f32 v74, v74
  v_exp_f32 v75, v75
  v_pk_fma_f32 v[68:69], v[68:69], v[204:205], v[204:205] op_sel_hi:[1,0,0]
  v_pk_fma_f32 v[70:71], v[70:71], v[204:205], v[204:205] op_sel_hi:[1,0,0]
  v_pk_fma_f32 v[72:73], v[72:73], v[204:205], v[204:205] op_sel_hi:[1,0,0]
  v_pk_fma_f32 v[74:75], v[74:75], v[204:205], v[204:205] op_sel_hi:[1,0,0]
  v_rcp_f32 v68, v68
  v_rcp_f32 v69, v69
  v_rcp_f32 v70, v70
  v_rcp_f32 v71, v71
  v_rcp_f32 v72, v72
  v_rcp_f32 v73, v73
  v_rcp_f32 v74, v74
  v_rcp_f32 v75, v75
  v_pk_mul_f32 v[68:69], v[68:69], v[28:29]
  v_pk_mul_f32 v[70:71], v[70:71], v[30:31]
  v_pk_mul_f32 v[72:73], v[72:73], v[32:33]
  v_pk_mul_f32 v[74:75], v[74:75], v[34:35]
  v_cvt_pk_bf16_f32 v16, v68, v69
  v_cvt_pk_bf16_f32 v17, v70, v71
  v_cvt_pk_bf16_f32 v18, v72, v73
  v_cvt_pk_bf16_f32 v19, v74, v75
  buffer_store_dwordx4 v[12:15], v249, s[28:31], s55 offen offset:0 sc1
  buffer_store_dwordx4 v[16:19], v249, s[28:31], s55 offen offset:2048 sc1
  v_pk_mul_f32 v[68:69], v[36:37], v[36:37]
  v_pk_mul_f32 v[70:71], v[38:39], v[38:39]
  v_pk_mul_f32 v[72:73], v[40:41], v[40:41]
  v_pk_mul_f32 v[74:75], v[42:43], v[42:43]
  v_pk_fma_f32 v[68:69], v[68:69], v[206:207], v[206:207] op_sel:[0,0,1] op_sel_hi:[1,0,1]
  v_pk_fma_f32 v[70:71], v[70:71], v[206:207], v[206:207] op_sel:[0,0,1] op_sel_hi:[1,0,1]
  v_pk_fma_f32 v[72:73], v[72:73], v[206:207], v[206:207] op_sel:[0,0,1] op_sel_hi:[1,0,1]
  v_pk_fma_f32 v[74:75], v[74:75], v[206:207], v[206:207] op_sel:[0,0,1] op_sel_hi:[1,0,1]
  v_pk_mul_f32 v[68:69], v[68:69], v[36:37]
  v_pk_mul_f32 v[70:71], v[70:71], v[38:39]
  v_pk_mul_f32 v[72:73], v[72:73], v[40:41]
  v_pk_mul_f32 v[74:75], v[74:75], v[42:43]
  v_exp_f32 v68, v68
  v_exp_f32 v69, v69
  v_exp_f32 v70, v70
  v_exp_f32 v71, v71
  v_exp_f32 v72, v72
  v_exp_f32 v73, v73
  v_exp_f32 v74, v74
  v_exp_f32 v75, v75
  v_pk_fma_f32 v[68:69], v[68:69], v[204:205], v[204:205] op_sel_hi:[1,0,0]
  v_pk_fma_f32 v[70:71], v[70:71], v[204:205], v[204:205] op_sel_hi:[1,0,0]
  v_pk_fma_f32 v[72:73], v[72:73], v[204:205], v[204:205] op_sel_hi:[1,0,0]
  v_pk_fma_f32 v[74:75], v[74:75], v[204:205], v[204:205] op_sel_hi:[1,0,0]
  v_rcp_f32 v68, v68
  v_rcp_f32 v69, v69
  v_rcp_f32 v70, v70
  v_rcp_f32 v71, v71
  v_rcp_f32 v72, v72
  v_rcp_f32 v73, v73
  v_rcp_f32 v74, v74
  v_rcp_f32 v75, v75
  v_pk_mul_f32 v[68:69], v[68:69], v[36:37]
  v_pk_mul_f32 v[70:71], v[70:71], v[38:39]
  v_pk_mul_f32 v[72:73], v[72:73], v[40:41]
  v_pk_mul_f32 v[74:75], v[74:75], v[42:43]
  v_cvt_pk_bf16_f32 v4, v68, v69
  v_cvt_pk_bf16_f32 v5, v70, v71
  v_cvt_pk_bf16_f32 v6, v72, v73
  v_cvt_pk_bf16_f32 v7, v74, v75
  v_pk_mul_f32 v[68:69], v[44:45], v[44:45]
  v_pk_mul_f32 v[70:71], v[46:47], v[46:47]
  v_pk_mul_f32 v[72:73], v[48:49], v[48:49]
  v_pk_mul_f32 v[74:75], v[50:51], v[50:51]
  v_pk_fma_f32 v[68:69], v[68:69], v[206:207], v[206:207] op_sel:[0,0,1] op_sel_hi:[1,0,1]
  v_pk_fma_f32 v[70:71], v[70:71], v[206:207], v[206:207] op_sel:[0,0,1] op_sel_hi:[1,0,1]
  v_pk_fma_f32 v[72:73], v[72:73], v[206:207], v[206:207] op_sel:[0,0,1] op_sel_hi:[1,0,1]
  v_pk_fma_f32 v[74:75], v[74:75], v[206:207], v[206:207] op_sel:[0,0,1] op_sel_hi:[1,0,1]
  v_pk_mul_f32 v[68:69], v[68:69], v[44:45]
  v_pk_mul_f32 v[70:71], v[70:71], v[46:47]
  v_pk_mul_f32 v[72:73], v[72:73], v[48:49]
  v_pk_mul_f32 v[74:75], v[74:75], v[50:51]
  v_exp_f32 v68, v68
  v_exp_f32 v69, v69
  v_exp_f32 v70, v70
  v_exp_f32 v71, v71
  v_exp_f32 v72, v72
  v_exp_f32 v73, v73
  v_exp_f32 v74, v74
  v_exp_f32 v75, v75
  v_pk_fma_f32 v[68:69], v[68:69], v[204:205], v[204:205] op_sel_hi:[1,0,0]
  v_pk_fma_f32 v[70:71], v[70:71], v[204:205], v[204:205] op_sel_hi:[1,0,0]
  v_pk_fma_f32 v[72:73], v[72:73], v[204:205], v[204:205] op_sel_hi:[1,0,0]
  v_pk_fma_f32 v[74:75], v[74:75], v[204:205], v[204:205] op_sel_hi:[1,0,0]
  v_rcp_f32 v68, v68
  v_rcp_f32 v69, v69
  v_rcp_f32 v70, v70
  v_rcp_f32 v71, v71
  v_rcp_f32 v72, v72
  v_rcp_f32 v73, v73
  v_rcp_f32 v74, v74
  v_rcp_f32 v75, v75
  v_pk_mul_f32 v[68:69], v[68:69], v[44:45]
  v_pk_mul_f32 v[70:71], v[70:71], v[46:47]
  v_pk_mul_f32 v[72:73], v[72:73], v[48:49]
  v_pk_mul_f32 v[74:75], v[74:75], v[50:51]
  v_cvt_pk_bf16_f32 v8, v68, v69
  v_cvt_pk_bf16_f32 v9, v70, v71
  v_cvt_pk_bf16_f32 v10, v72, v73
  v_cvt_pk_bf16_f32 v11, v74, v75
  s_add_u32 s55, s55, 0x1000
  buffer_store_dwordx4 v[4:7], v249, s[28:31], s55 offen offset:0 sc1
  buffer_store_dwordx4 v[8:11], v249, s[28:31], s55 offen offset:2048 sc1
  s_cmp_lg_u32 s57, 0
  s_cbranch_scc1 Lskip3_50
  v_pk_mul_f32 v[68:69], v[52:53], v[52:53]
  v_pk_mul_f32 v[70:71], v[54:55], v[54:55]
  v_pk_mul_f32 v[72:73], v[56:57], v[56:57]
  v_pk_mul_f32 v[74:75], v[58:59], v[58:59]
  v_pk_fma_f32 v[68:69], v[68:69], v[206:207], v[206:207] op_sel:[0,0,1] op_sel_hi:[1,0,1]
  v_pk_fma_f32 v[70:71], v[70:71], v[206:207], v[206:207] op_sel:[0,0,1] op_sel_hi:[1,0,1]
  v_pk_fma_f32 v[72:73], v[72:73], v[206:207], v[206:207] op_sel:[0,0,1] op_sel_hi:[1,0,1]
  v_pk_fma_f32 v[74:75], v[74:75], v[206:207], v[206:207] op_sel:[0,0,1] op_sel_hi:[1,0,1]
  v_pk_mul_f32 v[68:69], v[68:69], v[52:53]
  v_pk_mul_f32 v[70:71], v[70:71], v[54:55]
  v_pk_mul_f32 v[72:73], v[72:73], v[56:57]
  v_pk_mul_f32 v[74:75], v[74:75], v[58:59]
  v_exp_f32 v68, v68
  v_exp_f32 v69, v69
  v_exp_f32 v70, v70
  v_exp_f32 v71, v71
  v_exp_f32 v72, v72
  v_exp_f32 v73, v73
  v_exp_f32 v74, v74
  v_exp_f32 v75, v75
  v_pk_fma_f32 v[68:69], v[68:69], v[204:205], v[204:205] op_sel_hi:[1,0,0]
  v_pk_fma_f32 v[70:71], v[70:71], v[204:205], v[204:205] op_sel_hi:[1,0,0]
  v_pk_fma_f32 v[72:73], v[72:73], v[204:205], v[204:205] op_sel_hi:[1,0,0]
  v_pk_fma_f32 v[74:75], v[74:75], v[204:205], v[204:205] op_sel_hi:[1,0,0]
  v_rcp_f32 v68, v68
  v_rcp_f32 v69, v69
  v_rcp_f32 v70, v70
  v_rcp_f32 v71, v71
  v_rcp_f32 v72, v72
  v_rcp_f32 v73, v73
  v_rcp_f32 v74, v74
  v_rcp_f32 v75, v75
  v_pk_mul_f32 v[68:69], v[68:69], v[52:53]
  v_pk_mul_f32 v[70:71], v[70:71], v[54:55]
  v_pk_mul_f32 v[72:73], v[72:73], v[56:57]
  v_pk_mul_f32 v[74:75], v[74:75], v[58:59]
  v_cvt_pk_bf16_f32 v12, v68, v69
  v_cvt_pk_bf16_f32 v13, v70, v71
  v_cvt_pk_bf16_f32 v14, v72, v73
  v_cvt_pk_bf16_f32 v15, v74, v75
  v_pk_mul_f32 v[68:69], v[60:61], v[60:61]
  v_pk_mul_f32 v[70:71], v[62:63], v[62:63]
  v_pk_mul_f32 v[72:73], v[64:65], v[64:65]
  v_pk_mul_f32 v[74:75], v[66:67], v[66:67]
  v_pk_fma_f32 v[68:69], v[68:69], v[206:207], v[206:207] op_sel:[0,0,1] op_sel_hi:[1,0,1]
  v_pk_fma_f32 v[70:71], v[70:71], v[206:207], v[206:207] op_sel:[0,0,1] op_sel_hi:[1,0,1]
  v_pk_fma_f32 v[72:73], v[72:73], v[206:207], v[206:207] op_sel:[0,0,1] op_sel_hi:[1,0,1]
  v_pk_fma_f32 v[74:75], v[74:75], v[206:207], v[206:207] op_sel:[0,0,1] op_sel_hi:[1,0,1]
  v_pk_mul_f32 v[68:69], v[68:69], v[60:61]
  v_pk_mul_f32 v[70:71], v[70:71], v[62:63]
  v_pk_mul_f32 v[72:73], v[72:73], v[64:65]
  v_pk_mul_f32 v[74:75], v[74:75], v[66:67]
  v_exp_f32 v68, v68
  v_exp_f32 v69, v69
  v_exp_f32 v70, v70
  v_exp_f32 v71, v71
  v_exp_f32 v72, v72
  v_exp_f32 v73, v73
  v_exp_f32 v74, v74
  v_exp_f32 v75, v75
  v_pk_fma_f32 v[68:69], v[68:69], v[204:205], v[204:205] op_sel_hi:[1,0,0]
  v_pk_fma_f32 v[70:71], v[70:71], v[204:205], v[204:205] op_sel_hi:[1,0,0]
  v_pk_fma_f32 v[72:73], v[72:73], v[204:205], v[204:205] op_sel_hi:[1,0,0]
  v_pk_fma_f32 v[74:75], v[74:75], v[204:205], v[204:205] op_sel_hi:[1,0,0]
  v_rcp_f32 v68, v68
  v_rcp_f32 v69, v69
  v_rcp_f32 v70, v70
  v_rcp_f32 v71, v71
  v_rcp_f32 v72, v72
  v_rcp_f32 v73, v73
  v_rcp_f32 v74, v74
  v_rcp_f32 v75, v75
  v_pk_mul_f32 v[68:69], v[68:69], v[60:61]
  v_pk_mul_f32 v[70:71], v[70:71], v[62:63]
  v_pk_mul_f32 v[72:73], v[72:73], v[64:65]
  v_pk_mul_f32 v[74:75], v[74:75], v[66:67]
  v_cvt_pk_bf16_f32 v16, v68, v69
  v_cvt_pk_bf16_f32 v17, v70, v71
  v_cvt_pk_bf16_f32 v18, v72, v73
  v_cvt_pk_bf16_f32 v19, v74, v75
  s_add_u32 s55, s55, 0x1000
  buffer_store_dwordx4 v[12:15], v249, s[28:31], s55 offen offset:0 sc1
  buffer_store_dwordx4 v[16:19], v249, s[28:31], s55 offen offset:2048 sc1
Lskip3_50:
  s_barrier
  v_bfe_u32 v255, v0, 2, 2
  v_lshl_add_u32 v255, v247, 3, v255
  v_xor_b32 v254, s60, v225
  v_and_b32 v253, 1, v247
  v_lshl_add_u32 v254, v254, 1, v253
  v_bfe_u32 v252, v0, 1, 1
  v_lshl_add_u32 v254, v254, 1, v252
  v_and_b32 v251, 1, v0
  v_lshlrev_b32 v251, 3, v251
  v_lshl_add_u32 v254, v254, 4, v251
  v_lshl_add_u32 v222, v255, 7, v254
  v_xor_b32 v246, 32, v222
  v_add_u32 v221, 0x10000, v222
  v_add_u32 v220, 0x20000, v222
  v_add_u32 v245, 0x10000, v246
  v_add_u32 v244, 0x20000, v246
  v_lshlrev_b32 v4, 16, v152
  v_and_b32 v5, 0xffff0000, v152
  v_lshlrev_b32 v6, 16, v153
  v_and_b32 v7, 0xffff0000, v153
  v_lshlrev_b32 v8, 16, v154
  v_and_b32 v9, 0xffff0000, v154
  v_lshlrev_b32 v10, 16, v155
  v_and_b32 v11, 0xffff0000, v155
  v_lshlrev_b32 v12, 16, v156
  v_and_b32 v13, 0xffff0000, v156
  v_lshlrev_b32 v14, 16, v157
  v_and_b32 v15, 0xffff0000, v157
  v_lshlrev_b32 v16, 16, v158
  v_and_b32 v17, 0xffff0000, v158
  v_lshlrev_b32 v18, 16, v159
  v_and_b32 v19, 0xffff0000, v159
  ds_read_b64_tr_b16 v[44:45], v221 offset:16384
  ds_read_b64_tr_b16 v[46:47], v221 offset:16896
  ds_read_b64_tr_b16 v[48:49], v245 offset:16384
  ds_read_b64_tr_b16 v[50:51], v245 offset:16896
  ds_read_b64_tr_b16 v[52:53], v221 offset:20480
  ds_read_b64_tr_b16 v[54:55], v221 offset:20992
  ds_read_b64_tr_b16 v[56:57], v245 offset:20480
  ds_read_b64_tr_b16 v[58:59], v245 offset:20992
  ds_read_b64_tr_b16 v[60:61], v221 offset:24576
  ds_read_b64_tr_b16 v[62:63], v221 offset:25088
  ds_read_b64_tr_b16 v[64:65], v245 offset:24576
  ds_read_b64_tr_b16 v[66:67], v245 offset:25088
  ds_read_b64_tr_b16 v[68:69], v221 offset:28672
  ds_read_b64_tr_b16 v[70:71], v221 offset:29184
  ds_read_b64_tr_b16 v[72:73], v245 offset:28672
  ds_read_b64_tr_b16 v[74:75], v245 offset:29184
  ds_read_b64_tr_b16 v[76:77], v221 offset:40960
  ds_read_b64_tr_b16 v[78:79], v221 offset:41472
  ds_read_b64_tr_b16 v[80:81], v245 offset:40960
  ds_read_b64_tr_b16 v[82:83], v245 offset:41472
  ds_read_b64_tr_b16 v[84:85], v221 offset:45056
  ds_read_b64_tr_b16 v[86:87], v221 offset:45568
  ds_read_b64_tr_b16 v[88:89], v245 offset:45056
  ds_read_b64_tr_b16 v[90:91], v245 offset:45568
  s_barrier
  ds_read_b64_tr_b16 v[92:93], v221 offset:49152
  ds_read_b64_tr_b16 v[94:95], v221 offset:49664
  ds_read_b64_tr_b16 v[96:97], v245 offset:49152
  ds_read_b64_tr_b16 v[98:99], v245 offset:49664
  ds_read_b64_tr_b16 v[100:101], v221 offset:53248
  ds_read_b64_tr_b16 v[102:103], v221 offset:53760
  ds_read_b64_tr_b16 v[104:105], v245 offset:53248
  ds_read_b64_tr_b16 v[106:107], v245 offset:53760
  ds_read_b64_tr_b16 v[108:109], v221 offset:57344
  ds_read_b64_tr_b16 v[110:111], v221 offset:57856
  ds_read_b64_tr_b16 v[112:113], v245 offset:57344
  ds_read_b64_tr_b16 v[114:115], v245 offset:57856
  ds_read_b64_tr_b16 v[116:117], v221 offset:61440
  ds_read_b64_tr_b16 v[118:119], v221 offset:61952
  ds_read_b64_tr_b16 v[120:121], v245 offset:61440
  ds_read_b64_tr_b16 v[122:123], v245 offset:61952
  ds_read_b64_tr_b16 v[124:125], v222 offset:0
  ds_read_b64_tr_b16 v[126:127], v222 offset:512
  ds_read_b64_tr_b16 v[128:129], v246 offset:0
  ds_read_b64_tr_b16 v[130:131], v246 offset:512
  ds_read_b64_tr_b16 v[132:133], v222 offset:4096
  ds_read_b64_tr_b16 v[134:135], v222 offset:4608
  ds_read_b64_tr_b16 v[136:137], v246 offset:4096
  ds_read_b64_tr_b16 v[138:139], v246 offset:4608
  s_waitcnt vmcnt(0)
  s_waitcnt lgkmcnt(0)
  s_barrier
  ds_read_b64_tr_b16 v[140:141], v222 offset:8192
  ds_read_b64_tr_b16 v[142:143], v222 offset:8704
  ds_read_b64_tr_b16 v[152:153], v246 offset:8192
  ds_read_b64_tr_b16 v[154:155], v246 offset:8704
  ds_read_b64_tr_b16 v[156:157], v222 offset:12288
  ds_read_b64_tr_b16 v[158:159], v222 offset:12800
  ds_read_b64_tr_b16 v[160:161], v246 offset:12288
  ds_read_b64_tr_b16 v[162:163], v246 offset:12800
  ds_read_b64_tr_b16 v[164:165], v222 offset:16384
  ds_read_b64_tr_b16 v[166:167], v222 offset:16896
  ds_read_b64_tr_b16 v[168:169], v246 offset:16384
  ds_read_b64_tr_b16 v[170:171], v246 offset:16896
  ds_read_b64_tr_b16 v[172:173], v222 offset:20480
  ds_read_b64_tr_b16 v[174:175], v222 offset:20992
  ds_read_b64_tr_b16 v[176:177], v246 offset:20480
  ds_read_b64_tr_b16 v[178:179], v246 offset:20992
  ds_read_b64_tr_b16 v[180:181], v220 offset:0
  ds_read_b64_tr_b16 v[182:183], v220 offset:512
  ds_read_b64_tr_b16 v[184:185], v244 offset:0
  ds_read_b64_tr_b16 v[186:187], v244 offset:512
  ds_read_b64_tr_b16 v[188:189], v220 offset:4096
  ds_read_b64_tr_b16 v[190:191], v220 offset:4608
  ds_read_b64_tr_b16 v[192:193], v244 offset:4096
  ds_read_b64_tr_b16 v[194:195], v244 offset:4608
  ds_read_b64_tr_b16 v[196:197], v222 offset:24576
  ds_read_b64_tr_b16 v[198:199], v222 offset:25088
  ds_read_b64_tr_b16 v[200:201], v246 offset:24576
  ds_read_b64_tr_b16 v[202:203], v246 offset:25088
  ds_read_b64_tr_b16 v[204:205], v222 offset:28672
  ds_read_b64_tr_b16 v[206:207], v222 offset:29184
  ds_read_b64_tr_b16 v[208:209], v246 offset:28672
  ds_read_b64_tr_b16 v[210:211], v246 offset:29184
  ds_read_b64_tr_b16 v[226:227], v222 offset:32768
  ds_read_b64_tr_b16 v[228:229], v222 offset:33280
  ds_read_b64_tr_b16 v[230:231], v246 offset:32768
  ds_read_b64_tr_b16 v[232:233], v246 offset:33280
  ds_read_b64_tr_b16 v[234:235], v222 offset:36864
  ds_read_b64_tr_b16 v[236:237], v222 offset:37376
  ds_read_b64_tr_b16 v[238:239], v246 offset:36864
  ds_read_b64_tr_b16 v[240:241], v246 offset:37376
  s_waitcnt lgkmcnt(0)
  s_cmp_lg_u32 s51, 0
  s_cbranch_scc1 Lnopoll_51
  s_lshl_b32 s63, s48, 12
  s_add_u32 s63, s63, 0xe00800
  s_add_u32 s44, s28, s63
  s_addc_u32 s45, s29, 0
  s_add_u32 s34, s65, 3
  s_mov_b32 s35, s34
  s_waitcnt lgkmcnt(0)
  s_mov_b32 s59, 0
Lspoll_53:
  s_load_dwordx8 s[36:43], s[44:45], s59
  s_add_u32 s59, s59, 64
  s_waitcnt lgkmcnt(0)
  s_xor_b64 s[46:47], s[36:37], s[34:35]
  s_xor_b64 s[0:1], s[38:39], s[34:35]
  s_or_b64 s[46:47], s[46:47], s[0:1]
  s_xor_b64 s[0:1], s[40:41], s[34:35]
  s_or_b64 s[46:47], s[46:47], s[0:1]
  s_xor_b64 s[0:1], s[42:43], s[34:35]
  s_or_b64 s[46:47], s[46:47], s[0:1]
  s_cbranch_scc0 Lpollok_52
  s_cmp_lt_u32 s59, 1024
  s_cbranch_scc1 Lspoll_53
  v_and_b32 v250, 28, v215
  s_mov_b32 s59, 0
Lpoll_54:
  buffer_load_dword v255, v250, s[28:31], s63 offen sc1
  s_waitcnt vmcnt(0)
  v_cmp_eq_u32 vcc, s34, v255
  s_add_u32 s59, s59, 1
  s_cmp_eq_u64 vcc, exec
  s_cbranch_scc1 Lpollok_55
  s_cmp_lt_u32 s59, 0x40000
  s_cbranch_scc1 Lpoll_54
Lpollok_55:
Lpollok_52:
Lnopoll_51:
  s_barrier
  v_lshrrev_b32 v255, 1, v247
  v_lshlrev_b32 v254, 11, v255
  v_and_b32 v253, 1, v247
  v_lshl_add_u32 v254, v253, 9, v254
  v_lshl_add_u32 v254, v248, 4, v254
  s_lshl_b32 s3, s52, 10
  v_add_u32 v219, s3, v254
  v_add_u32 v218, 0x10000, v219
  v_add_u32 v217, 0x20000, v219
  v_bfe_u32 v254, v0, 2, 2
  v_lshl_add_u32 v254, v247, 2, v254
  v_xor_b32 v252, s52, v225
  v_bfe_u32 v251, v0, 1, 1
  v_lshl_add_u32 v252, v252, 2, v251
  v_and_b32 v251, 1, v0
  v_lshlrev_b32 v251, 3, v251
  v_lshl_add_u32 v252, v252, 4, v251
  v_lshl_add_u32 v254, v254, 7, v252
  s_lshl_b32 s3, s60, 12
  s_add_u32 s3, s3, 0x18000
  v_add_u32 v243, s3, v254
  s_lshl_b32 s3, s51, 11
  s_add_u32 s3, s3, 0x24000
  v_bfe_u32 v254, v0, 1, 2
  v_xor_b32 v255, v255, v254
  v_lshlrev_b32 v255, 4, v255
  v_lshl_add_u32 v255, v253, 3, v255
  v_lshl_add_u32 v255, v248, 6, v255
  v_add_u32 v255, s3, v255
  v_xor_b32 v254, 32, v255
  v_bfe_u32 v253, v0, 3, 2
  v_and_b32 v252, 3, v0
  v_xor_b32 v253, v253, v252
  v_lshrrev_b32 v251, 2, v0
  v_lshlrev_b32 v253, 4, v253
  v_lshl_add_u32 v253, v251, 6, v253
  v_add_u32 v253, s3, v253
  s_lshl_b32 s3, s52, 15
  v_lshlrev_b32 v252, 4, v252
  v_lshl_add_u32 v252, v251, 10, v252
  v_add_u32 v242, s3, v252
  s_lshl_b32 s3, s60, 6
  v_add_u32 v242, s3, v242
  s_barrier
  ds_read_b128 v[20:23], v218 offset:0
  ds_read_b128 v[24:27], v218 offset:256
  ds_read_b128 v[28:31], v218 offset:4096
  ds_read_b128 v[32:35], v218 offset:4352
  s_waitcnt lgkmcnt(2)
  v_mfma_f32_16x16x32_bf16 v[4:7], v[44:47], v[20:23], v[4:7]
  s_barrier
  ds_read_b128 v[36:39], v219 offset:49152
  v_mfma_f32_16x16x32_bf16 v[8:11], v[44:47], v[24:27], v[8:11]
  ds_read_b128 v[40:43], v219 offset:49408
  v_mfma_f32_16x16x32_bf16 v[12:15], v[48:51], v[20:23], v[12:15]
  v_mfma_f32_16x16x32_bf16 v[16:19], v[48:51], v[24:27], v[16:19]
  s_waitcnt lgkmcnt(2)
  v_mfma_f32_16x16x32_bf16 v[4:7], v[52:55], v[28:31], v[4:7]
  ds_read_b128 v[20:23], v219 offset:53248
  v_mfma_f32_16x16x32_bf16 v[8:11], v[52:55], v[32:35], v[8:11]
  ds_read_b128 v[24:27], v219 offset:53504
  v_mfma_f32_16x16x32_bf16 v[12:15], v[56:59], v[28:31], v[12:15]
  v_mfma_f32_16x16x32_bf16 v[16:19], v[56:59], v[32:35], v[16:19]
  s_waitcnt lgkmcnt(2)
  v_mfma_f32_16x16x32_bf16 v[4:7], v[60:63], v[36:39], v[4:7]
  s_barrier
  ds_read_b128 v[28:31], v219 offset:57344
  v_mfma_f32_16x16x32_bf16 v[8:11], v[60:63], v[40:43], v[8:11]
  ds_read_b128 v[32:35], v219 offset:57600
  v_mfma_f32_16x16x32_bf16 v[12:15], v[64:67], v[36:39], v[12:15]
  v_mfma_f32_16x16x32_bf16 v[16:19], v[64:67], v[40:43], v[16:19]
  s_waitcnt lgkmcnt(2)
  v_mfma_f32_16x16x32_bf16 v[4:7], v[68:71], v[20:23], v[4:7]
  ds_read_b128 v[36:39], v219 offset:61440
  v_mfma_f32_16x16x32_bf16 v[8:11], v[68:71], v[24:27], v[8:11]
  ds_read_b128 v[40:43], v219 offset:61696
  v_mfma_f32_16x16x32_bf16 v[12:15], v[72:75], v[20:23], v[12:15]
  v_mfma_f32_16x16x32_bf16 v[16:19], v[72:75], v[24:27], v[16:19]
  s_waitcnt lgkmcnt(2)
  v_mfma_f32_16x16x32_bf16 v[4:7], v[76:79], v[28:31], v[4:7]
  s_barrier
  ds_read_b128 v[20:23], v217 offset:16384
  v_mfma_f32_16x16x32_bf16 v[8:11], v[76:79], v[32:35], v[8:11]
  ds_read_b128 v[24:27], v217 offset:16640
  v_mfma_f32_16x16x32_bf16 v[12:15], v[80:83], v[28:31], v[12:15]
  v_mfma_f32_16x16x32_bf16 v[16:19], v[80:83], v[32:35], v[16:19]
  s_waitcnt lgkmcnt(2)
  v_mfma_f32_16x16x32_bf16 v[4:7], v[84:87], v[36:39], v[4:7]
  ds_read_b128 v[28:31], v217 offset:20480
  v_mfma_f32_16x16x32_bf16 v[8:11], v[84:87], v[40:43], v[8:11]
  ds_read_b128 v[32:35], v217 offset:20736
  v_mfma_f32_16x16x32_bf16 v[12:15], v[88:91], v[36:39], v[12:15]
  v_mfma_f32_16x16x32_bf16 v[16:19], v[88:91], v[40:43], v[16:19]
  s_waitcnt lgkmcnt(2)
  v_mfma_f32_16x16x32_bf16 v[4:7], v[92:95], v[20:23], v[4:7]
  s_barrier
  ds_read_b128 v[36:39], v217 offset:0
  v_mfma_f32_16x16x32_bf16 v[8:11], v[92:95], v[24:27], v[8:11]
  ds_read_b128 v[40:43], v217 offset:256
  v_mfma_f32_16x16x32_bf16 v[12:15], v[96:99], v[20:23], v[12:15]
  v_mfma_f32_16x16x32_bf16 v[16:19], v[96:99], v[24:27], v[16:19]
  v_lshlrev_b32 v212, 16, v144
  v_and_b32 v213, 0xffff0000, v144
  s_waitcnt lgkmcnt(2)
  v_mfma_f32_16x16x32_bf16 v[4:7], v[100:103], v[28:31], v[4:7]
  ds_read_b128 v[20:23], v217 offset:4096
  v_mfma_f32_16x16x32_bf16 v[8:11], v[100:103], v[32:35], v[8:11]
  ds_read_b128 v[24:27], v217 offset:4352
  v_mfma_f32_16x16x32_bf16 v[12:15], v[104:107], v[28:31], v[12:15]
  v_mfma_f32_16x16x32_bf16 v[16:19], v[104:107], v[32:35], v[16:19]
  v_lshlrev_b32 v90, 16, v145
  v_and_b32 v91, 0xffff0000, v145
  s_waitcnt lgkmcnt(2)
  v_mfma_f32_16x16x32_bf16 v[4:7], v[108:111], v[36:39], v[4:7]
  s_barrier
  ds_read_b128 v[28:31], v219 offset:24576
  v_mfma_f32_16x16x32_bf16 v[8:11], v[108:111], v[40:43], v[8:11]
  ds_read_b128 v[32:35], v219 offset:24832
  v_mfma_f32_16x16x32_bf16 v[12:15], v[112:115], v[36:39], v[12:15]
  v_mfma_f32_16x16x32_bf16 v[16:19], v[112:115], v[40:43], v[16:19]
  v_lshlrev_b32 v88, 16, v146
  v_and_b32 v89, 0xffff0000, v146
  s_waitcnt lgkmcnt(2)
  v_mfma_f32_16x16x32_bf16 v[4:7], v[116:119], v[20:23], v[4:7]
  ds_read_b128 v[36:39], v219 offset:28672
  v_mfma_f32_16x16x32_bf16 v[8:11], v[116:119], v[24:27], v[8:11]
  ds_read_b128 v[40:43], v219 offset:28928
  v_mfma_f32_16x16x32_bf16 v[12:15], v[120:123], v[20:23], v[12:15]
  v_mfma_f32_16x16x32_bf16 v[16:19], v[120:123], v[24:27], v[16:19]
  v_lshlrev_b32 v86, 16, v147
  v_and_b32 v87, 0xffff0000, v147
  s_waitcnt lgkmcnt(2)
  v_mfma_f32_16x16x32_bf16 v[4:7], v[124:127], v[28:31], v[4:7]
  s_barrier
  ds_read_b128 v[20:23], v219 offset:32768
  v_mfma_f32_16x16x32_bf16 v[8:11], v[124:127], v[32:35], v[8:11]
  ds_read_b128 v[24:27], v219 offset:33024
  v_mfma_f32_16x16x32_bf16 v[12:15], v[128:131], v[28:31], v[12:15]
  v_mfma_f32_16x16x32_bf16 v[16:19], v[128:131], v[32:35], v[16:19]
  v_lshlrev_b32 v84, 16, v148
  v_and_b32 v85, 0xffff0000, v148
  s_waitcnt lgkmcnt(2)
  v_mfma_f32_16x16x32_bf16 v[4:7], v[132:135], v[36:39], v[4:7]
  ds_read_b128 v[28:31], v219 offset:36864
  v_mfma_f32_16x16x32_bf16 v[8:11], v[132:135], v[40:43], v[8:11]
  ds_read_b128 v[32:35], v219 offset:37120
  v_mfma_f32_16x16x32_bf16 v[12:15], v[136:139], v[36:39], v[12:15]
  v_mfma_f32_16x16x32_bf16 v[16:19], v[136:139], v[40:43], v[16:19]
  v_lshlrev_b32 v82, 16, v149
  v_and_b32 v83, 0xffff0000, v149
  s_waitcnt lgkmcnt(2)
  v_mfma_f32_16x16x32_bf16 v[4:7], v[140:143], v[20:23], v[4:7]
  s_barrier
  ds_read_b128 v[36:39], v218 offset:0
  v_mfma_f32_16x16x32_bf16 v[8:11], v[140:143], v[24:27], v[8:11]
  ds_read_b128 v[40:43], v218 offset:256
  v_mfma_f32_16x16x32_bf16 v[12:15], v[152:155], v[20:23], v[12:15]
  v_mfma_f32_16x16x32_bf16 v[16:19], v[152:155], v[24:27], v[16:19]
  v_lshlrev_b32 v80, 16, v150
  v_and_b32 v81, 0xffff0000, v150
  s_waitcnt lgkmcnt(2)
  v_mfma_f32_16x16x32_bf16 v[4:7], v[156:159], v[28:31], v[4:7]
  ds_read_b128 v[20:23], v218 offset:4096
  v_mfma_f32_16x16x32_bf16 v[8:11], v[156:159], v[32:35], v[8:11]
  ds_read_b128 v[24:27], v218 offset:4352
  v_mfma_f32_16x16x32_bf16 v[12:15], v[160:163], v[28:31], v[12:15]
  v_mfma_f32_16x16x32_bf16 v[16:19], v[160:163], v[32:35], v[16:19]
  v_lshlrev_b32 v78, 16, v151
  v_and_b32 v79, 0xffff0000, v151
  s_waitcnt lgkmcnt(2)
  v_mfma_f32_16x16x32_bf16 v[4:7], v[164:167], v[36:39], v[4:7]
  s_barrier
  ds_read_b128 v[28:31], v219 offset:49152
  v_mfma_f32_16x16x32_bf16 v[8:11], v[164:167], v[40:43], v[8:11]
  ds_read_b128 v[32:35], v219 offset:49408
  v_mfma_f32_16x16x32_bf16 v[12:15], v[168:171], v[36:39], v[12:15]
  v_mfma_f32_16x16x32_bf16 v[16:19], v[168:171], v[40:43], v[16:19]
  s_waitcnt lgkmcnt(2)
  v_mfma_f32_16x16x32_bf16 v[4:7], v[172:175], v[20:23], v[4:7]
  ds_read_b128 v[36:39], v219 offset:53248
  v_mfma_f32_16x16x32_bf16 v[8:11], v[172:175], v[24:27], v[8:11]
  ds_read_b128 v[40:43], v219 offset:53504
  v_mfma_f32_16x16x32_bf16 v[12:15], v[176:179], v[20:23], v[12:15]
  v_mfma_f32_16x16x32_bf16 v[16:19], v[176:179], v[24:27], v[16:19]
  s_waitcnt lgkmcnt(2)
  v_mfma_f32_16x16x32_bf16 v[4:7], v[180:183], v[28:31], v[4:7]
  s_barrier
  ds_read_b128 v[20:23], v219 offset:57344
  v_mfma_f32_16x16x32_bf16 v[8:11], v[180:183], v[32:35], v[8:11]
  ds_read_b128 v[24:27], v219 offset:57600
  v_mfma_f32_16x16x32_bf16 v[12:15], v[184:187], v[28:31], v[12:15]
  v_mfma_f32_16x16x32_bf16 v[16:19], v[184:187], v[32:35], v[16:19]
  s_waitcnt lgkmcnt(2)
  v_mfma_f32_16x16x32_bf16 v[4:7], v[188:191], v[36:39], v[4:7]
  ds_read_b128 v[28:31], v219 offset:61440
  v_mfma_f32_16x16x32_bf16 v[8:11], v[188:191], v[40:43], v[8:11]
  ds_read_b128 v[32:35], v219 offset:61696
  v_mfma_f32_16x16x32_bf16 v[12:15], v[192:195], v[36:39], v[12:15]
  v_mfma_f32_16x16x32_bf16 v[16:19], v[192:195], v[40:43], v[16:19]
  s_waitcnt lgkmcnt(2)
  v_mfma_f32_16x16x32_bf16 v[4:7], v[196:199], v[20:23], v[4:7]
  s_barrier
  ds_read_b128 v[36:39], v217 offset:16384
  v_mfma_f32_16x16x32_bf16 v[8:11], v[196:199], v[24:27], v[8:11]
  ds_read_b128 v[40:43], v217 offset:16640
  v_mfma_f32_16x16x32_bf16 v[12:15], v[200:203], v[20:23], v[12:15]
  v_mfma_f32_16x16x32_bf16 v[16:19], v[200:203], v[24:27], v[16:19]
  s_waitcnt lgkmcnt(2)
  v_mfma_f32_16x16x32_bf16 v[4:7], v[204:207], v[28:31], v[4:7]
  ds_read_b128 v[20:23], v217 offset:20480
  v_mfma_f32_16x16x32_bf16 v[8:11], v[204:207], v[32:35], v[8:11]
  ds_read_b128 v[24:27], v217 offset:20736
  v_mfma_f32_16x16x32_bf16 v[12:15], v[208:211], v[28:31], v[12:15]
  v_mfma_f32_16x16x32_bf16 v[16:19], v[208:211], v[32:35], v[16:19]
  s_waitcnt lgkmcnt(2)
  v_mfma_f32_16x16x32_bf16 v[4:7], v[226:229], v[36:39], v[4:7]
  s_barrier
  ds_read_b128 v[28:31], v217 offset:0
  ds_read_b128 v[32:35], v217 offset:256
  v_mfma_f32_16x16x32_bf16 v[8:11], v[226:229], v[40:43], v[8:11]
  ds_read_b64_tr_b16 v[52:53], v222 offset:40960
  ds_read_b64_tr_b16 v[54:55], v222 offset:41472
  v_mfma_f32_16x16x32_bf16 v[12:15], v[230:233], v[36:39], v[12:15]
  ds_read_b64_tr_b16 v[56:57], v246 offset:40960
  v_mfma_f32_16x16x32_bf16 v[16:19], v[230:233], v[40:43], v[16:19]
  ds_read_b64_tr_b16 v[58:59], v246 offset:41472
  s_waitcnt lgkmcnt(6)
  v_mfma_f32_16x16x32_bf16 v[4:7], v[234:237], v[20:23], v[4:7]
  ds_read_b128 v[36:39], v217 offset:4096
  ds_read_b128 v[40:43], v217 offset:4352
  v_mfma_f32_16x16x32_bf16 v[8:11], v[234:237], v[24:27], v[8:11]
  ds_read_b64_tr_b16 v[60:61], v222 offset:45056
  ds_read_b64_tr_b16 v[62:63], v222 offset:45568
  v_mfma_f32_16x16x32_bf16 v[12:15], v[238:241], v[20:23], v[12:15]
  ds_read_b64_tr_b16 v[64:65], v246 offset:45056
  v_mfma_f32_16x16x32_bf16 v[16:19], v[238:241], v[24:27], v[16:19]
  ds_read_b64_tr_b16 v[66:67], v246 offset:45568
  s_waitcnt lgkmcnt(6)
  v_mfma_f32_16x16x32_bf16 v[4:7], v[52:55], v[28:31], v[4:7]
  s_barrier
  ds_read_b128 v[20:23], v219 offset:24576
  ds_read_b128 v[24:27], v219 offset:24832
  v_mfma_f32_16x16x32_bf16 v[8:11], v[52:55], v[32:35], v[8:11]
  ds_read_b64_tr_b16 v[44:45], v220 offset:8192
  ds_read_b64_tr_b16 v[46:47], v220 offset:8704
  v_mfma_f32_16x16x32_bf16 v[12:15], v[56:59], v[28:31], v[12:15]
  ds_read_b64_tr_b16 v[48:49], v244 offset:8192
  v_mfma_f32_16x16x32_bf16 v[16:19], v[56:59], v[32:35], v[16:19]
  ds_read_b64_tr_b16 v[50:51], v244 offset:8704
  s_waitcnt lgkmcnt(6)
  v_mfma_f32_16x16x32_bf16 v[4:7], v[60:63], v[36:39], v[4:7]
  ds_read_b128 v[28:31], v219 offset:28672
  ds_read_b128 v[32:35], v219 offset:28928
  v_mfma_f32_16x16x32_bf16 v[8:11], v[60:63], v[40:43], v[8:11]
  ds_read_b64_tr_b16 v[52:53], v220 offset:12288
  ds_read_b64_tr_b16 v[54:55], v220 offset:12800
  v_mfma_f32_16x16x32_bf16 v[12:15], v[64:67], v[36:39], v[12:15]
  ds_read_b64_tr_b16 v[56:57], v244 offset:12288
  v_mfma_f32_16x16x32_bf16 v[16:19], v[64:67], v[40:43], v[16:19]
  ds_read_b64_tr_b16 v[58:59], v244 offset:12800
  s_waitcnt lgkmcnt(6)
  v_mfma_f32_16x16x32_bf16 v[4:7], v[44:47], v[20:23], v[4:7]
  s_barrier
  ds_read_b128 v[36:39], v219 offset:32768
  ds_read_b128 v[40:43], v219 offset:33024
  v_mfma_f32_16x16x32_bf16 v[8:11], v[44:47], v[24:27], v[8:11]
  ds_read_b64_tr_b16 v[60:61], v221 offset:8192
  ds_read_b64_tr_b16 v[62:63], v221 offset:8704
  v_mfma_f32_16x16x32_bf16 v[12:15], v[48:51], v[20:23], v[12:15]
  ds_read_b64_tr_b16 v[64:65], v245 offset:8192
  v_mfma_f32_16x16x32_bf16 v[16:19], v[48:51], v[24:27], v[16:19]
  ds_read_b64_tr_b16 v[66:67], v245 offset:8704
  s_waitcnt lgkmcnt(6)
  v_mfma_f32_16x16x32_bf16 v[4:7], v[52:55], v[28:31], v[4:7]
  ds_read_b128 v[20:23], v219 offset:36864
  ds_read_b128 v[24:27], v219 offset:37120
  v_mfma_f32_16x16x32_bf16 v[8:11], v[52:55], v[32:35], v[8:11]
  ds_read_b64_tr_b16 v[44:45], v221 offset:12288
  ds_read_b64_tr_b16 v[46:47], v221 offset:12800
  v_mfma_f32_16x16x32_bf16 v[12:15], v[56:59], v[28:31], v[12:15]
  ds_read_b64_tr_b16 v[48:49], v245 offset:12288
  v_mfma_f32_16x16x32_bf16 v[16:19], v[56:59], v[32:35], v[16:19]
  ds_read_b64_tr_b16 v[50:51], v245 offset:12800
  s_waitcnt lgkmcnt(6)
  v_mfma_f32_16x16x32_bf16 v[4:7], v[60:63], v[36:39], v[4:7]
  s_barrier
  ds_read_b128 v[28:31], v218 offset:0
  ds_read_b128 v[32:35], v218 offset:256
  v_mfma_f32_16x16x32_bf16 v[8:11], v[60:63], v[40:43], v[8:11]
  ds_read_b64_tr_b16 v[52:53], v221 offset:16384
  ds_read_b64_tr_b16 v[54:55], v221 offset:16896
  v_mfma_f32_16x16x32_bf16 v[12:15], v[64:67], v[36:39], v[12:15]
  ds_read_b64_tr_b16 v[56:57], v245 offset:16384
  v_mfma_f32_16x16x32_bf16 v[16:19], v[64:67], v[40:43], v[16:19]
  ds_read_b64_tr_b16 v[58:59], v245 offset:16896
  s_waitcnt lgkmcnt(6)
  v_mfma_f32_16x16x32_bf16 v[4:7], v[44:47], v[20:23], v[4:7]
  ds_read_b128 v[36:39], v218 offset:4096
  ds_read_b128 v[40:43], v218 offset:4352
  v_mfma_f32_16x16x32_bf16 v[8:11], v[44:47], v[24:27], v[8:11]
  ds_read_b64_tr_b16 v[60:61], v221 offset:20480
  ds_read_b64_tr_b16 v[62:63], v221 offset:20992
  v_mfma_f32_16x16x32_bf16 v[12:15], v[48:51], v[20:23], v[12:15]
  ds_read_b64_tr_b16 v[64:65], v245 offset:20480
  v_mfma_f32_16x16x32_bf16 v[16:19], v[48:51], v[24:27], v[16:19]
  ds_read_b64_tr_b16 v[66:67], v245 offset:20992
  s_waitcnt lgkmcnt(6)
  v_mfma_f32_16x16x32_bf16 v[4:7], v[52:55], v[28:31], v[4:7]
  s_barrier
  ds_read_b128 v[20:23], v219 offset:49152
  ds_read_b128 v[24:27], v219 offset:49408
  v_mfma_f32_16x16x32_bf16 v[8:11], v[52:55], v[32:35], v[8:11]
  ds_read_b64_tr_b16 v[44:45], v221 offset:24576
  ds_read_b64_tr_b16 v[46:47], v221 offset:25088
  v_mfma_f32_16x16x32_bf16 v[12:15], v[56:59], v[28:31], v[12:15]
  ds_read_b64_tr_b16 v[48:49], v245 offset:24576
  v_mfma_f32_16x16x32_bf16 v[16:19], v[56:59], v[32:35], v[16:19]
  ds_read_b64_tr_b16 v[50:51], v245 offset:25088
  s_waitcnt lgkmcnt(6)
  v_mfma_f32_16x16x32_bf16 v[4:7], v[60:63], v[36:39], v[4:7]
  ds_read_b128 v[28:31], v219 offset:53248
  ds_read_b128 v[32:35], v219 offset:53504
  v_mfma_f32_16x16x32_bf16 v[8:11], v[60:63], v[40:43], v[8:11]
  ds_read_b64_tr_b16 v[52:53], v221 offset:28672
  ds_read_b64_tr_b16 v[54:55], v221 offset:29184
  v_mfma_f32_16x16x32_bf16 v[12:15], v[64:67], v[36:39], v[12:15]
  ds_read_b64_tr_b16 v[56:57], v245 offset:28672
  v_mfma_f32_16x16x32_bf16 v[16:19], v[64:67], v[40:43], v[16:19]
  ds_read_b64_tr_b16 v[58:59], v245 offset:29184
  s_waitcnt lgkmcnt(6)
  v_mfma_f32_16x16x32_bf16 v[4:7], v[44:47], v[20:23], v[4:7]
  s_barrier
  ds_read_b128 v[36:39], v219 offset:57344
  ds_read_b128 v[40:43], v219 offset:57600
  v_mfma_f32_16x16x32_bf16 v[8:11], v[44:47], v[24:27], v[8:11]
  ds_read_b64_tr_b16 v[60:61], v221 offset:40960
  ds_read_b64_tr_b16 v[62:63], v221 offset:41472
  v_mfma_f32_16x16x32_bf16 v[12:15], v[48:51], v[20:23], v[12:15]
  ds_read_b64_tr_b16 v[64:65], v245 offset:40960
  v_mfma_f32_16x16x32_bf16 v[16:19], v[48:51], v[24:27], v[16:19]
  ds_read_b64_tr_b16 v[66:67], v245 offset:41472
  s_waitcnt lgkmcnt(6)
  v_mfma_f32_16x16x32_bf16 v[4:7], v[52:55], v[28:31], v[4:7]
  ds_read_b128 v[20:23], v219 offset:61440
  ds_read_b128 v[24:27], v219 offset:61696
  v_mfma_f32_16x16x32_bf16 v[8:11], v[52:55], v[32:35], v[8:11]
  ds_read_b64_tr_b16 v[44:45], v221 offset:45056
  ds_read_b64_tr_b16 v[46:47], v221 offset:45568
  v_mfma_f32_16x16x32_bf16 v[12:15], v[56:59], v[28:31], v[12:15]
  ds_read_b64_tr_b16 v[48:49], v245 offset:45056
  v_mfma_f32_16x16x32_bf16 v[16:19], v[56:59], v[32:35], v[16:19]
  ds_read_b64_tr_b16 v[50:51], v245 offset:45568
  s_waitcnt lgkmcnt(6)
  v_mfma_f32_16x16x32_bf16 v[4:7], v[60:63], v[36:39], v[4:7]
  s_barrier
  ds_read_b128 v[28:31], v217 offset:16384
  ds_read_b128 v[32:35], v217 offset:16640
  v_mfma_f32_16x16x32_bf16 v[8:11], v[60:63], v[40:43], v[8:11]
  ds_read_b64_tr_b16 v[52:53], v221 offset:49152
  ds_read_b64_tr_b16 v[54:55], v221 offset:49664
  v_mfma_f32_16x16x32_bf16 v[12:15], v[64:67], v[36:39], v[12:15]
  ds_read_b64_tr_b16 v[56:57], v245 offset:49152
  v_mfma_f32_16x16x32_bf16 v[16:19], v[64:67], v[40:43], v[16:19]
  ds_read_b64_tr_b16 v[58:59], v245 offset:49664
  s_waitcnt lgkmcnt(6)
  v_mfma_f32_16x16x32_bf16 v[4:7], v[44:47], v[20:23], v[4:7]
  ds_read_b128 v[36:39], v217 offset:20480
  ds_read_b128 v[40:43], v217 offset:20736
  v_mfma_f32_16x16x32_bf16 v[8:11], v[44:47], v[24:27], v[8:11]
  ds_read_b64_tr_b16 v[60:61], v221 offset:53248
  ds_read_b64_tr_b16 v[62:63], v221 offset:53760
  v_mfma_f32_16x16x32_bf16 v[12:15], v[48:51], v[20:23], v[12:15]
  ds_read_b64_tr_b16 v[64:65], v245 offset:53248
  v_mfma_f32_16x16x32_bf16 v[16:19], v[48:51], v[24:27], v[16:19]
  ds_read_b64_tr_b16 v[66:67], v245 offset:53760
  s_waitcnt lgkmcnt(6)
  v_mfma_f32_16x16x32_bf16 v[4:7], v[52:55], v[28:31], v[4:7]
  s_barrier
  ds_read_b128 v[20:23], v217 offset:0
  ds_read_b128 v[24:27], v217 offset:256
  v_mfma_f32_16x16x32_bf16 v[8:11], v[52:55], v[32:35], v[8:11]
  ds_read_b64_tr_b16 v[44:45], v221 offset:57344
  ds_read_b64_tr_b16 v[46:47], v221 offset:57856
  v_mfma_f32_16x16x32_bf16 v[12:15], v[56:59], v[28:31], v[12:15]
  ds_read_b64_tr_b16 v[48:49], v245 offset:57344
  v_mfma_f32_16x16x32_bf16 v[16:19], v[56:59], v[32:35], v[16:19]
  ds_read_b64_tr_b16 v[50:51], v245 offset:57856
  s_waitcnt lgkmcnt(6)
  v_mfma_f32_16x16x32_bf16 v[4:7], v[60:63], v[36:39], v[4:7]
  ds_read_b128 v[28:31], v217 offset:4096
  ds_read_b128 v[32:35], v217 offset:4352
  v_mfma_f32_16x16x32_bf16 v[8:11], v[60:63], v[40:43], v[8:11]
  ds_read_b64_tr_b16 v[52:53], v221 offset:61440
  ds_read_b64_tr_b16 v[54:55], v221 offset:61952
  v_mfma_f32_16x16x32_bf16 v[12:15], v[64:67], v[36:39], v[12:15]
  ds_read_b64_tr_b16 v[56:57], v245 offset:61440
  v_mfma_f32_16x16x32_bf16 v[16:19], v[64:67], v[40:43], v[16:19]
  ds_read_b64_tr_b16 v[58:59], v245 offset:61952
  s_waitcnt lgkmcnt(6)
  v_mfma_f32_16x16x32_bf16 v[4:7], v[44:47], v[20:23], v[4:7]
  s_barrier
  ds_read_b128 v[36:39], v219 offset:40960
  ds_read_b128 v[40:43], v219 offset:41216
  v_mfma_f32_16x16x32_bf16 v[8:11], v[44:47], v[24:27], v[8:11]
  ds_read_b64_tr_b16 v[60:61], v222 offset:0
  ds_read_b64_tr_b16 v[62:63], v222 offset:512
  v_mfma_f32_16x16x32_bf16 v[12:15], v[48:51], v[20:23], v[12:15]
  ds_read_b64_tr_b16 v[64:65], v246 offset:0
  v_mfma_f32_16x16x32_bf16 v[16:19], v[48:51], v[24:27], v[16:19]
  ds_read_b64_tr_b16 v[66:67], v246 offset:512
  s_waitcnt lgkmcnt(6)
  v_mfma_f32_16x16x32_bf16 v[4:7], v[52:55], v[28:31], v[4:7]
  ds_read_b128 v[20:23], v219 offset:45056
  ds_read_b128 v[24:27], v219 offset:45312
  v_mfma_f32_16x16x32_bf16 v[8:11], v[52:55], v[32:35], v[8:11]
  ds_read_b64_tr_b16 v[44:45], v222 offset:4096
  ds_read_b64_tr_b16 v[46:47], v222 offset:4608
  v_mfma_f32_16x16x32_bf16 v[12:15], v[56:59], v[28:31], v[12:15]
  ds_read_b64_tr_b16 v[48:49], v246 offset:4096
  v_mfma_f32_16x16x32_bf16 v[16:19], v[56:59], v[32:35], v[16:19]
  ds_read_b64_tr_b16 v[50:51], v246 offset:4608
  s_waitcnt lgkmcnt(6)
  v_mfma_f32_16x16x32_bf16 v[4:7], v[60:63], v[36:39], v[4:7]
  s_barrier
  ds_read_b128 v[28:31], v219 offset:24576
  ds_read_b128 v[32:35], v219 offset:24832
  v_mfma_f32_16x16x32_bf16 v[8:11], v[60:63], v[40:43], v[8:11]
  ds_read_b64_tr_b16 v[52:53], v222 offset:8192
  ds_read_b64_tr_b16 v[54:55], v222 offset:8704
  v_mfma_f32_16x16x32_bf16 v[12:15], v[64:67], v[36:39], v[12:15]
  ds_read_b64_tr_b16 v[56:57], v246 offset:8192
  v_mfma_f32_16x16x32_bf16 v[16:19], v[64:67], v[40:43], v[16:19]
  ds_read_b64_tr_b16 v[58:59], v246 offset:8704
  s_waitcnt lgkmcnt(6)
  v_mfma_f32_16x16x32_bf16 v[4:7], v[44:47], v[20:23], v[4:7]
  ds_read_b128 v[36:39], v219 offset:28672
  ds_read_b128 v[40:43], v219 offset:28928
  v_mfma_f32_16x16x32_bf16 v[8:11], v[44:47], v[24:27], v[8:11]
  ds_read_b64_tr_b16 v[60:61], v222 offset:12288
  ds_read_b64_tr_b16 v[62:63], v222 offset:12800
  v_mfma_f32_16x16x32_bf16 v[12:15], v[48:51], v[20:23], v[12:15]
  ds_read_b64_tr_b16 v[64:65], v246 offset:12288
  v_mfma_f32_16x16x32_bf16 v[16:19], v[48:51], v[24:27], v[16:19]
  ds_read_b64_tr_b16 v[66:67], v246 offset:12800
  s_waitcnt lgkmcnt(6)
  v_mfma_f32_16x16x32_bf16 v[4:7], v[52:55], v[28:31], v[4:7]
  s_barrier
  ds_read_b128 v[20:23], v217 offset:8192
  ds_read_b128 v[24:27], v217 offset:8448
  v_mfma_f32_16x16x32_bf16 v[8:11], v[52:55], v[32:35], v[8:11]
  ds_read_b64_tr_b16 v[44:45], v222 offset:16384
  ds_read_b64_tr_b16 v[46:47], v222 offset:16896
  v_mfma_f32_16x16x32_bf16 v[12:15], v[56:59], v[28:31], v[12:15]
  ds_read_b64_tr_b16 v[48:49], v246 offset:16384
  v_mfma_f32_16x16x32_bf16 v[16:19], v[56:59], v[32:35], v[16:19]
  ds_read_b64_tr_b16 v[50:51], v246 offset:16896
  ds_read_b64_tr_b16 v[68:69], v243 offset:0
  ds_read_b64_tr_b16 v[70:71], v243 offset:32
  ds_read_b64_tr_b16 v[72:73], v243 offset:2048
  ds_read_b64_tr_b16 v[74:75], v243 offset:2080
  s_waitcnt lgkmcnt(10)
  v_mfma_f32_16x16x32_bf16 v[4:7], v[60:63], v[36:39], v[4:7]
  v_mfma_f32_16x16x32_bf16 v[8:11], v[60:63], v[40:43], v[8:11]
  v_mfma_f32_16x16x32_bf16 v[12:15], v[64:67], v[36:39], v[12:15]
  v_mfma_f32_16x16x32_bf16 v[16:19], v[64:67], v[40:43], v[16:19]
  s_waitcnt lgkmcnt(0)
  v_lshlrev_b32 v240, 16, v68
  v_and_b32 v241, 0xffff0000, v68
  v_lshlrev_b32 v238, 16, v69
  v_and_b32 v239, 0xffff0000, v69
  v_lshlrev_b32 v232, 16, v72
  v_and_b32 v233, 0xffff0000, v72
  v_lshlrev_b32 v230, 16, v73
  v_and_b32 v231, 0xffff0000, v73
  v_mfma_f32_16x16x32_bf16 v[4:7], v[44:47], v[20:23], v[4:7]
  v_mfma_f32_16x16x32_bf16 v[8:11], v[44:47], v[24:27], v[8:11]
  v_mfma_f32_16x16x32_bf16 v[12:15], v[48:51], v[20:23], v[12:15]
  v_mfma_f32_16x16x32_bf16 v[16:19], v[48:51], v[24:27], v[16:19]
  v_lshlrev_b32 v236, 16, v70
  v_and_b32 v237, 0xffff0000, v70
  v_lshlrev_b32 v234, 16, v71
  v_and_b32 v235, 0xffff0000, v71
  v_lshlrev_b32 v228, 16, v74
  v_and_b32 v229, 0xffff0000, v74
  v_lshlrev_b32 v226, 16, v75
  v_and_b32 v227, 0xffff0000, v75
  s_mov_b32 s66, 0xbfb8aa3b
  s_lshl_b32 s3, s49, 7
  s_add_u32 s55, s3, s61
  s_add_u32 s56, s55, 0x4000
  v_pk_mul_f32 v[100:101], v[4:5], s[66:67] op_sel_hi:[1,0]
  v_pk_mul_f32 v[102:103], v[6:7], s[66:67] op_sel_hi:[1,0]
  v_pk_mul_f32 v[104:105], v[12:13], s[66:67] op_sel_hi:[1,0]
  v_pk_mul_f32 v[106:107], v[14:15], s[66:67] op_sel_hi:[1,0]
  v_exp_f32 v100, v100
  v_exp_f32 v101, v101
  v_exp_f32 v102, v102
  v_exp_f32 v103, v103
  v_exp_f32 v104, v104
  v_exp_f32 v105, v105
  v_exp_f32 v106, v106
  v_exp_f32 v107, v107
  v_pk_mul_f32 v[240:241], v[240:241], v[4:5]
  v_pk_mul_f32 v[238:239], v[238:239], v[6:7]
  v_pk_mul_f32 v[232:233], v[232:233], v[12:13]
  v_pk_mul_f32 v[230:231], v[230:231], v[14:15]
  v_pk_add_f32 v[100:101], v[100:101], 1.0 op_sel_hi:[1,0]
  v_pk_add_f32 v[102:103], v[102:103], 1.0 op_sel_hi:[1,0]
  v_pk_add_f32 v[104:105], v[104:105], 1.0 op_sel_hi:[1,0]
  v_pk_add_f32 v[106:107], v[106:107], 1.0 op_sel_hi:[1,0]
  v_rcp_f32 v100, v100
  v_rcp_f32 v101, v101
  v_rcp_f32 v102, v102
  v_rcp_f32 v103, v103
  v_rcp_f32 v104, v104
  v_rcp_f32 v105, v105
  v_rcp_f32 v106, v106
  v_rcp_f32 v107, v107
  v_pk_fma_f32 v[100:101], v[100:101], v[240:241], v[212:213]
  v_pk_fma_f32 v[102:103], v[102:103], v[238:239], v[90:91]
  v_pk_fma_f32 v[104:105], v[104:105], v[232:233], v[84:85]
  v_pk_fma_f32 v[106:107], v[106:107], v[230:231], v[82:83]
  v_cvt_pk_bf16_f32 v92, v100, v101
  v_cvt_pk_bf16_f32 v93, v102, v103
  v_cvt_pk_bf16_f32 v94, v104, v105
  v_cvt_pk_bf16_f32 v95, v106, v107
  ds_write_b64 v255, v[92:93] offset:0
  ds_write_b64 v254, v[94:95] offset:0
  ds_read_b128 v[68:71], v253 offset:0
  v_pk_mul_f32 v[100:101], v[8:9], s[66:67] op_sel_hi:[1,0]
  v_pk_mul_f32 v[102:103], v[10:11], s[66:67] op_sel_hi:[1,0]
  v_pk_mul_f32 v[104:105], v[16:17], s[66:67] op_sel_hi:[1,0]
  v_pk_mul_f32 v[106:107], v[18:19], s[66:67] op_sel_hi:[1,0]
  v_exp_f32 v100, v100
  v_exp_f32 v101, v101
  v_exp_f32 v102, v102
  v_exp_f32 v103, v103
  v_exp_f32 v104, v104
  v_exp_f32 v105, v105
  v_exp_f32 v106, v106
  v_exp_f32 v107, v107
  v_pk_mul_f32 v[236:237], v[236:237], v[8:9]
  v_pk_mul_f32 v[234:235], v[234:235], v[10:11]
  v_pk_mul_f32 v[228:229], v[228:229], v[16:17]
  v_pk_mul_f32 v[226:227], v[226:227], v[18:19]
  s_waitcnt lgkmcnt(0)
  buffer_store_dwordx4 v[68:71], v242, s[24:27], s55 offen
  v_pk_add_f32 v[100:101], v[100:101], 1.0 op_sel_hi:[1,0]
  v_pk_add_f32 v[102:103], v[102:103], 1.0 op_sel_hi:[1,0]
  v_pk_add_f32 v[104:105], v[104:105], 1.0 op_sel_hi:[1,0]
  v_pk_add_f32 v[106:107], v[106:107], 1.0 op_sel_hi:[1,0]
  v_rcp_f32 v100, v100
  v_rcp_f32 v101, v101
  v_rcp_f32 v102, v102
  v_rcp_f32 v103, v103
  v_rcp_f32 v104, v104
  v_rcp_f32 v105, v105
  v_rcp_f32 v106, v106
  v_rcp_f32 v107, v107
  v_pk_fma_f32 v[100:101], v[100:101], v[236:237], v[88:89]
  v_pk_fma_f32 v[102:103], v[102:103], v[234:235], v[86:87]
  v_pk_fma_f32 v[104:105], v[104:105], v[228:229], v[80:81]
  v_pk_fma_f32 v[106:107], v[106:107], v[226:227], v[78:79]
  v_cvt_pk_bf16_f32 v96, v100, v101
  v_cvt_pk_bf16_f32 v97, v102, v103
  v_cvt_pk_bf16_f32 v98, v104, v105
  v_cvt_pk_bf16_f32 v99, v106, v107
  ds_write_b64 v255, v[96:97] offset:1024
  ds_write_b64 v254, v[98:99] offset:1024
  ds_read_b128 v[72:75], v253 offset:1024
  s_waitcnt lgkmcnt(0)
  buffer_store_dwordx4 v[72:75], v242, s[24:27], s56 offen
LEND:
  s_endpgm
LCODE_END:
.section .rodata,"a"
.p2align 6
.amdhsa_kernel recurrent_scan__spectral_fnet__mixer_s_mlp__prompt_kernel
  .amdhsa_next_free_vgpr 256
  .amdhsa_next_free_sgpr 102
  .amdhsa_accum_offset 256
  .amdhsa_group_segment_fixed_size 0
  .amdhsa_kernarg_size 104
  .amdhsa_user_sgpr_count 2
  .amdhsa_user_sgpr_kernarg_segment_ptr 1
  .amdhsa_system_sgpr_workgroup_id_x 1
.end_amdhsa_kernel
```
